```python
import torch

def _softmax(x, axis=-1):
    return torch.softmax(x, dim=axis)
def _gelu(x):
    return torch.nn.functional.gelu(x, approximate="tanh")
def _silu(x):
    return torch.nn.functional.silu(x)
def _sigmoid(x):
    return torch.sigmoid(x)
def _layernorm(x, axis=-1, eps=1e-5):
    m = x.mean(dim=axis, keepdim=True)
    v = x.var(dim=axis, keepdim=True, unbiased=False)
    return (x - m) / torch.sqrt(v + eps)
def _scatter_add(tgt, idx, src, axis=0):
    return tgt.clone().index_add_(axis, idx, src)
def _segment_sum(src, seg, n):
    out = torch.zeros((n,) + src.shape[1:], dtype=src.dtype)
    return out.index_add_(0, seg, src)
def _pad(x, pw):
    flat = tuple(v for pair in reversed(pw) for v in pair)
    return torch.nn.functional.pad(x, flat)

kernel_name = 'parallel_sum__linear_attn_block__dense_activation_gelu__prompt'

def setup_inputs():

    _w = (lambda a: (lambda t: t.to(torch.bfloat16) if t.is_floating_point() else t)(torch.as_tensor(a)))
    def _A_setup():
        B, S, D = 1, 2048, 512
        return {
            "x": _w((lambda *s: torch.randn(*s, dtype=torch.bfloat16) * 0.05)(B, S, D)),
            "wqkv": _w((lambda *s: torch.randn(*s, dtype=torch.bfloat16) * 0.05)(D, 3 * D)),
            "wo": _w((lambda *s: torch.randn(*s, dtype=torch.bfloat16) * 0.05)(D, D)),
        }
    _A_in = _A_setup()

    def _B_setup():
        B, S, D, F = 1, 2048, 512, 1376
        return {
            "x": _w((lambda *s: torch.randn(*s, dtype=torch.bfloat16) * 0.05)(B, S, D)),
            "w1": _w((lambda *s: torch.randn(*s, dtype=torch.bfloat16) * 0.4)(D, F) * (D ** -0.5)),
            "b1": _w((lambda *s: torch.randn(*s, dtype=torch.bfloat16) * 12.8)(F) * 0.01),
            "w2": _w((lambda *s: torch.randn(*s, dtype=torch.bfloat16) * 0.1)(F, D) * (F ** -0.5)),
            "b2": _w((lambda *s: torch.randn(*s, dtype=torch.bfloat16) * 1.6)(D) * 0.01),
        }
    _B_in = _B_setup()

    return {
        "A_x": _A_in["x"],
        "A_wqkv": _A_in["wqkv"],
        "A_wo": _A_in["wo"],
        "B_x": _B_in["x"],
        "B_w1": _B_in["w1"],
        "B_b1": _B_in["b1"],
        "B_w2": _B_in["w2"],
        "B_b2": _B_in["b2"],
    }

def reference(A_x, A_wqkv, A_wo, B_x, B_w1, B_b1, B_w2, B_b2):
    def _A_ref(x, wqkv, wo):
        B, S, D = x.shape
        H = 32; Dh = D // H
        qkv = (lambda x, *d: x.permute(*d))((x @ wqkv).reshape(B, S, 3, H, Dh), 2, 0, 3, 1, 4)
        q, k, v = qkv[0], qkv[1], qkv[2]
        phi = lambda t: torch.where(t > 0, t + 1, torch.exp(t)) + 1e-6
        pq, pk = phi(q), phi(k)
        kv = torch.einsum("bhsd,bhse->bhde", pk, v)
        z = torch.einsum("bhsd->bhd", pk)
        num = torch.einsum("bhqd,bhde->bhqe", pq, kv)
        den = torch.einsum("bhqd,bhd->bhq", pq, z)[..., None] + 1e-6
        o = num / den
        return (lambda x, *d: x.permute(*d))(o, 0, 2, 1, 3).reshape(B, S, D) @ wo

    def _B_ref(x, w1, b1, w2, b2):
        h = torch.einsum("bsd,df->bsf", x, w1) + b1
        h = _gelu(h)
        return torch.einsum("bsf,fd->bsd", h, w2) + b2

    x = A_x
    xn = _layernorm(x, axis=-1)
    return x + _A_ref(xn, A_wqkv, A_wo) + _B_ref(xn, B_w1, B_b1, B_w2, B_b2)
```

```asm
; @launch grid=(256,1,1) block=(512,1,1) lds=142336
.amdgcn_target "amdgcn-amd-amdhsa--gfx950"
.text
.globl parallel_sum__linear_attn_block__dense_activation_gelu__prompt_kernel
.p2align 8
.type parallel_sum__linear_attn_block__dense_activation_gelu__prompt_kernel,@function
parallel_sum__linear_attn_block__dense_activation_gelu__prompt_kernel:
    s_cmp_ge_u32 s2, 256
    s_cbranch_scc1 K1_EXIT0
    s_load_dwordx4 s[28:31], s[0:1], 0
    s_load_dwordx4 s[32:35], s[0:1], 32
    s_load_dwordx4 s[36:39], s[0:1], 72
    s_load_dwordx2 s[82:83], s[0:1], 16
    s_load_dwordx2 s[84:85], s[0:1], 48
    s_load_dwordx4 s[92:95], s[0:1], 56
    v_lshrrev_b32 v1, 6, v0
    v_and_b32 v2, 63, v0
    v_readfirstlane_b32 s3, v1
    s_and_b32 s8, s2, 7
    s_lshr_b32 s9, s2, 3
    s_and_b32 s10, s9, 7
    s_lshr_b32 s11, s9, 3
    s_lshr_b32 s4, s8, 2
    s_lshl_b32 s4, s4, 3
    s_add_u32 s4, s4, s10
    s_and_b32 s5, s8, 3
    s_lshl_b32 s5, s5, 1
    s_and_b32 s12, s11, 1
    s_add_u32 s5, s5, s12
    s_lshr_b32 s7, s11, 1
    s_lshl_b32 s12, s7, 3
    s_add_u32 s5, s5, s12
    s_mul_i32 s6, s11, 0
    s_add_u32 s6, s6, s10
    s_and_b32 s6, s6, 7
    s_and_b32 s12, s5, 7
    s_mul_i32 s13, s12, 6
    s_mul_i32 s14, s12, 5
    s_add_u32 s14, s14, 3
    s_min_u32 s44, s13, s14
    s_cmp_lt_u32 s12, 3
    s_cselect_b32 s45, 6, 5
    s_lshl_b32 s13, s12, 7
    s_lshl_b32 s14, s44, 6
    s_mov_b32 s40, 2752
    s_mov_b32 s15, 128
    s_cmp_eq_u32 s7, 0
    s_cselect_b32 s40, 3072, s40
    s_cselect_b32 s41, s13, s14
    s_cselect_b32 s15, 1024, s15
    s_add_u32 s42, s41, s15
    s_add_u32 s43, s42, s15
    s_mov_b32 s64, 40960
    s_mov_b32 s65, 0xfffec000
    s_cmp_lt_u32 s3, 4
    s_cbranch_scc1 K1_CONS
    s_and_b32 s46, s3, 3
    v_lshrrev_b32 v3, 3, v2
    v_and_b32 v4, 7, v2
    v_lshrrev_b32 v5, 4, v2
    v_xor_b32 v6, v4, v5
    v_lshlrev_b32 v6, 4, v6
    v_lshl_add_u32 v10, v3, 10, v6
    s_lshl_b32 s47, s4, 17
    s_lshl_b32 s48, s46, 15
    s_add_u32 s47, s47, s48
    v_add_u32 v10, s47, v10
    v_xor_b32 v11, 64, v10
    v_add_u32 v11, 0x2000, v11
    v_add_u32 v12, 0x4000, v10
    v_add_u32 v13, 0x4000, v11
    v_and_b32 v5, 1, v5
    v_lshlrev_b32 v5, 2, v5
    v_xor_b32 v4, v4, v5
    v_lshlrev_b32 v4, 4, v4
    s_lshl_b32 s47, s46, 4
    v_add_u32 v14, s47, v3
    v_mul_lo_u32 v14, v14, s40
    v_add_u32 v14, v14, v4
    s_lshl_b32 s47, s40, 3
    v_add_u32 v15, s47, v14
    s_lshl_b32 s54, s46, 12
    s_lshl_b32 s55, s46, 11
    s_add_u32 s55, s55, 16384
    s_lshl_b32 s56, s40, 6
    s_mov_b32 s48, s6
    s_mov_b32 s53, 0
    s_lshl_b32 s49, s48, 7
    s_mul_i32 s50, s48, s56
    s_add_u32 s51, s50, s42
    s_add_u32 s52, s50, s43
    s_add_u32 s50, s50, s41
    s_add_u32 s58, s53, s54
    s_add_u32 s59, s53, s55
    s_add_u32 s48, s48, 1
    s_and_b32 s48, s48, 7
    s_add_u32 s53, s53, s64
    s_cmp_eq_u32 s53, 122880
    s_cselect_b32 s53, 0, s53
    s_waitcnt lgkmcnt(0)
    s_mov_b32 s8, s28
    s_and_b32 s9, s29, 0xffff
    s_mov_b32 s10, 2097152
    s_mov_b32 s11, 0x20000
    s_cmp_eq_u32 s7, 0
    s_cselect_b32 s12, s30, s32
    s_cselect_b32 s13, s31, s33
    s_mov_b32 s14, 1409024
    s_cselect_b32 s14, 1572864, s14
    s_and_b32 s13, s13, 0xffff
    s_mov_b32 s15, 0x20000
    s_add_u32 m0, s58, 0
    s_nop 0
    buffer_load_dwordx4 v10, s[8:11], s49 offen lds
    s_add_u32 m0, s58, 1024
    s_nop 0
    buffer_load_dwordx4 v11, s[8:11], s49 offen lds
    s_add_u32 m0, s58, 2048
    s_nop 0
    buffer_load_dwordx4 v12, s[8:11], s49 offen lds
    s_add_u32 m0, s58, 3072
    s_nop 0
    buffer_load_dwordx4 v13, s[8:11], s49 offen lds
    s_add_u32 m0, s59, 0
    s_nop 0
    buffer_load_dwordx4 v14, s[12:15], s50 offen lds
    s_add_u32 m0, s59, 1024
    s_nop 0
    buffer_load_dwordx4 v15, s[12:15], s50 offen lds
    s_add_u32 m0, s59, 8192
    s_nop 0
    buffer_load_dwordx4 v14, s[12:15], s51 offen lds
    s_add_u32 m0, s59, 9216
    s_nop 0
    buffer_load_dwordx4 v15, s[12:15], s51 offen lds
    s_add_u32 m0, s59, 16384
    s_nop 0
    buffer_load_dwordx4 v14, s[12:15], s52 offen lds
    s_add_u32 m0, s59, 17408
    s_nop 0
    buffer_load_dwordx4 v15, s[12:15], s52 offen lds
    s_lshl_b32 s49, s48, 7
    s_mul_i32 s50, s48, s56
    s_add_u32 s51, s50, s42
    s_add_u32 s52, s50, s43
    s_add_u32 s50, s50, s41
    s_add_u32 s58, s53, s54
    s_add_u32 s59, s53, s55
    s_add_u32 s48, s48, 1
    s_and_b32 s48, s48, 7
    s_add_u32 s53, s53, s64
    s_cmp_eq_u32 s53, 122880
    s_cselect_b32 s53, 0, s53
    s_add_u32 m0, s58, 0
    s_nop 0
    buffer_load_dwordx4 v10, s[8:11], s49 offen lds
    s_add_u32 m0, s58, 1024
    s_nop 0
    buffer_load_dwordx4 v11, s[8:11], s49 offen lds
    s_add_u32 m0, s58, 2048
    s_nop 0
    buffer_load_dwordx4 v12, s[8:11], s49 offen lds
    s_add_u32 m0, s58, 3072
    s_nop 0
    buffer_load_dwordx4 v13, s[8:11], s49 offen lds
    s_add_u32 m0, s59, 0
    s_nop 0
    buffer_load_dwordx4 v14, s[12:15], s50 offen lds
    s_add_u32 m0, s59, 1024
    s_nop 0
    buffer_load_dwordx4 v15, s[12:15], s50 offen lds
    s_add_u32 m0, s59, 8192
    s_nop 0
    buffer_load_dwordx4 v14, s[12:15], s51 offen lds
    s_add_u32 m0, s59, 9216
    s_nop 0
    buffer_load_dwordx4 v15, s[12:15], s51 offen lds
    s_add_u32 m0, s59, 16384
    s_nop 0
    buffer_load_dwordx4 v14, s[12:15], s52 offen lds
    s_add_u32 m0, s59, 17408
    s_nop 0
    buffer_load_dwordx4 v15, s[12:15], s52 offen lds
    s_mov_b32 s16, s38
    s_and_b32 s17, s39, 0xffff
    s_mov_b32 s18, 8072192
    s_mov_b32 s19, 0x20000
    s_mov_b32 s24, s36
    s_and_b32 s25, s37, 0xffff
    s_mov_b32 s26, 256
    s_mov_b32 s27, 0x20000
    s_mov_b32 s20, s34
    s_and_b32 s21, s35, 0xffff
    s_mov_b32 s22, 2752
    s_mov_b32 s23, 0x20000
    v_lshrrev_b32 v4, 5, v2
    v_and_b32 v6, 15, v2
    v_lshrrev_b32 v6, 2, v6
    v_lshl_add_u32 v6, v4, 3, v6
    v_lshlrev_b32 v6, 7, v6
    v_and_b32 v7, 3, v2
    v_lshlrev_b32 v7, 3, v7
    v_bfe_u32 v8, v2, 4, 1
    v_lshl_add_u32 v7, v8, 5, v7
    v_bfe_u32 v8, v2, 3, 1
    v_lshlrev_b32 v8, 6, v8
    s_mul_i32 s60, s46, 3
    s_add_u32 s60, s60, 0
    s_lshr_b32 s61, s60, 1
    s_and_b32 s60, s60, 1
    s_cmp_eq_u32 s7, 0
    s_cselect_b32 s61, 0, s61
    s_cselect_b32 s60, s46, s60
    s_lshl_b32 s61, s61, 13
    s_add_u32 s61, s61, 16384
    s_lshl_b32 s60, s60, 6
    v_add_u32 v9, s60, v7
    v_xor_b32 v9, v9, v8
    v_add3_u32 v16, v9, v6, s61
    s_mul_i32 s60, s46, 3
    s_add_u32 s60, s60, 1
    s_lshr_b32 s61, s60, 1
    s_and_b32 s60, s60, 1
    s_cmp_eq_u32 s7, 0
    s_cselect_b32 s61, 1, s61
    s_cselect_b32 s60, s46, s60
    s_lshl_b32 s61, s61, 13
    s_add_u32 s61, s61, 16384
    s_lshl_b32 s60, s60, 6
    v_add_u32 v9, s60, v7
    v_xor_b32 v9, v9, v8
    v_add3_u32 v17, v9, v6, s61
    s_mul_i32 s60, s46, 3
    s_add_u32 s60, s60, 2
    s_lshr_b32 s61, s60, 1
    s_and_b32 s60, s60, 1
    s_cmp_eq_u32 s7, 0
    s_cselect_b32 s61, 2, s61
    s_cselect_b32 s60, s46, s60
    s_lshl_b32 s61, s61, 13
    s_add_u32 s61, s61, 16384
    s_lshl_b32 s60, s60, 6
    v_add_u32 v9, s60, v7
    v_xor_b32 v9, v9, v8
    v_add3_u32 v18, v9, v6, s61
    s_lshr_b32 s60, s4, 3
    s_lshl_b32 s60, s60, 12
    v_add_u32 v16, s60, v16
    v_add_u32 v17, s60, v17
    v_add_u32 v18, s60, v18
    v_lshrrev_b32 v5, 4, v2
    v_xor_b32 v5, v5, v2
    v_and_b32 v5, 1, v5
    v_cmp_eq_u32 vcc, 0, v5
    v_mov_b32 v6, 0x3f803f80
    v_mov_b32 v19, 192
    s_lshl_b32 s60, s5, 2
    v_mov_b32 v26, s60
    v_mov_b32 v25, 0
    v_cndmask_b32 v20, 0, v6, vcc
    v_mov_b32 v21, v20
    v_mov_b32 v22, v20
    v_mov_b32 v23, v20
    s_lshl_b32 s49, s48, 7
    s_mul_i32 s50, s48, s56
    s_add_u32 s51, s50, s42
    s_add_u32 s52, s50, s43
    s_add_u32 s50, s50, s41
    s_add_u32 s58, s53, s54
    s_add_u32 s59, s53, s55
    s_add_u32 s48, s48, 1
    s_and_b32 s48, s48, 7
    s_add_u32 s53, s53, s64
    s_cmp_eq_u32 s53, 122880
    s_cselect_b32 s53, 0, s53
    s_waitcnt vmcnt(10)
    s_barrier
    s_cmp_lg_u32 s46, 3
    s_cbranch_scc1 K1_NNL
    buffer_load_dword v24, v19, s[24:27], 0 offen sc1
K1_NNL:
    s_add_u32 m0, s58, 0
    s_nop 0
    buffer_load_dwordx4 v10, s[8:11], s49 offen lds
    s_add_u32 m0, s58, 1024
    s_nop 0
    buffer_load_dwordx4 v11, s[8:11], s49 offen lds
    s_add_u32 m0, s58, 2048
    s_nop 0
    buffer_load_dwordx4 v12, s[8:11], s49 offen lds
    s_add_u32 m0, s58, 3072
    s_nop 0
    buffer_load_dwordx4 v13, s[8:11], s49 offen lds
    s_add_u32 m0, s59, 0
    s_nop 0
    buffer_load_dwordx4 v14, s[12:15], s50 offen lds
    s_add_u32 m0, s59, 1024
    s_nop 0
    buffer_load_dwordx4 v15, s[12:15], s50 offen lds
    s_add_u32 m0, s59, 8192
    s_nop 0
    buffer_load_dwordx4 v14, s[12:15], s51 offen lds
    s_add_u32 m0, s59, 9216
    s_nop 0
    buffer_load_dwordx4 v15, s[12:15], s51 offen lds
    s_add_u32 m0, s59, 16384
    s_nop 0
    buffer_load_dwordx4 v14, s[12:15], s52 offen lds
    s_add_u32 m0, s59, 17408
    s_nop 0
    buffer_load_dwordx4 v15, s[12:15], s52 offen lds
    s_cmp_ge_u32 s46, 2
    s_cbranch_scc1 K1_NOCS
    ds_read_b64_tr_b16 v[24:25], v16 offset:0
    ds_read_b64_tr_b16 v[26:27], v16 offset:512
    ds_read_b64_tr_b16 v[28:29], v16 offset:2048
    ds_read_b64_tr_b16 v[30:31], v16 offset:2560
    ds_read_b64_tr_b16 v[32:33], v17 offset:0
    ds_read_b64_tr_b16 v[34:35], v17 offset:512
    ds_read_b64_tr_b16 v[36:37], v17 offset:2048
    ds_read_b64_tr_b16 v[38:39], v17 offset:2560
    ds_read_b64_tr_b16 v[40:41], v18 offset:0
    ds_read_b64_tr_b16 v[42:43], v18 offset:512
    ds_read_b64_tr_b16 v[44:45], v18 offset:2048
    ds_read_b64_tr_b16 v[46:47], v18 offset:2560
    s_waitcnt lgkmcnt(0)
    v_mfma_f32_16x16x32_bf16 v[48:51], v[20:23], v[24:27], 0
    v_mfma_f32_16x16x32_bf16 v[52:55], v[20:23], v[32:35], 0
    v_mfma_f32_16x16x32_bf16 v[56:59], v[20:23], v[40:43], 0
    v_mfma_f32_16x16x32_bf16 v[48:51], v[20:23], v[28:31], v[48:51]
    v_mfma_f32_16x16x32_bf16 v[52:55], v[20:23], v[36:39], v[52:55]
    v_mfma_f32_16x16x32_bf16 v[56:59], v[20:23], v[44:47], v[56:59]
    v_and_b32 v5, 16, v2
    v_cmp_ne_u32 vcc, 0, v5
    v_lshlrev_b32 v5, 4, v2
    s_lshl_b32 s60, s5, 4
    s_add_u32 s60, s60, s4
    s_lshl_b32 s60, s60, 1
    s_add_u32 s60, s60, s46
    s_lshl_b32 s60, s60, 9
    s_add_u32 s60, s60, 7802880
    s_mov_b32 s62, s60
    s_nop 1
    v_cndmask_b32 v60, v48, v49, vcc
    v_cndmask_b32 v61, v52, v53, vcc
    v_cndmask_b32 v62, v56, v57, vcc
K1_NOCS:
    s_mov_b32 s47, 5
K1_LM:
    s_lshl_b32 s49, s48, 7
    s_mul_i32 s50, s48, s56
    s_add_u32 s51, s50, s42
    s_add_u32 s52, s50, s43
    s_add_u32 s50, s50, s41
    s_add_u32 s58, s53, s54
    s_add_u32 s59, s53, s55
    s_add_u32 s48, s48, 1
    s_and_b32 s48, s48, 7
    s_add_u32 s53, s53, s64
    s_cmp_eq_u32 s53, 122880
    s_cselect_b32 s53, 0, s53
    s_waitcnt vmcnt(10)
    s_cmp_lg_u32 s47, 5
    s_cbranch_scc1 K1_NN2
    s_cmp_lg_u32 s46, 3
    s_cbranch_scc1 K1_NN2
    s_mov_b32 s61, 0x40000
K1_NPL:
    v_readfirstlane_b32 s63, v24
    s_sub_u32 s61, s61, 1
    s_cmp_lg_u32 s63, 0
    s_cbranch_scc1 K1_NPD
    s_cmp_eq_u32 s61, 0
    s_cbranch_scc1 K1_NPD
    s_sleep 2
    buffer_load_dword v24, v19, s[24:27], 0 offen sc1
    s_waitcnt vmcnt(0)
    s_branch K1_NPL
K1_NPD:
    v_mov_b32 v19, 122880
    ds_write_b32 v19, v24
    s_waitcnt lgkmcnt(0)
K1_NN2:
    s_cmp_lg_u32 s47, 1
    s_cbranch_scc1 K1_NF2
    s_cmp_lg_u32 s46, 2
    s_cbranch_scc1 K1_NF2
    s_cmp_lg_u32 s7, 0
    s_cbranch_scc1 K1_NF2
    s_mov_b32 s61, 0x40000
K1_FPL:
    v_readfirstlane_b32 s60, v25
    s_sub_u32 s61, s61, 1
    s_cmp_lg_u32 s60, 0
    s_cbranch_scc1 K1_NF2
    s_cmp_eq_u32 s61, 0
    s_cbranch_scc1 K1_NF2
    s_sleep 2
    buffer_load_dword v25, v26, s[24:27], 0 offen sc1
    s_waitcnt vmcnt(0)
    s_branch K1_FPL
K1_NF2:
    s_barrier
    s_cmp_lg_u32 s47, 2
    s_cbranch_scc1 K1_NF1
    s_cmp_lg_u32 s46, 2
    s_cbranch_scc1 K1_NF1
    buffer_load_dword v25, v26, s[24:27], 0 offen sc1
K1_NF1:
    s_add_u32 m0, s58, 0
    s_nop 0
    buffer_load_dwordx4 v10, s[8:11], s49 offen lds
    s_add_u32 m0, s58, 1024
    s_nop 0
    buffer_load_dwordx4 v11, s[8:11], s49 offen lds
    s_add_u32 m0, s58, 2048
    s_nop 0
    buffer_load_dwordx4 v12, s[8:11], s49 offen lds
    s_add_u32 m0, s58, 3072
    s_nop 0
    buffer_load_dwordx4 v13, s[8:11], s49 offen lds
    s_add_u32 m0, s59, 0
    s_nop 0
    buffer_load_dwordx4 v14, s[12:15], s50 offen lds
    s_add_u32 m0, s59, 1024
    s_nop 0
    buffer_load_dwordx4 v15, s[12:15], s50 offen lds
    s_add_u32 m0, s59, 8192
    s_nop 0
    buffer_load_dwordx4 v14, s[12:15], s51 offen lds
    s_add_u32 m0, s59, 9216
    s_nop 0
    buffer_load_dwordx4 v15, s[12:15], s51 offen lds
    s_add_u32 m0, s59, 16384
    s_nop 0
    buffer_load_dwordx4 v14, s[12:15], s52 offen lds
    s_add_u32 m0, s59, 17408
    s_nop 0
    buffer_load_dwordx4 v15, s[12:15], s52 offen lds
    s_cmp_lg_u32 s47, 5
    s_cbranch_scc1 K1_NN3
    v_mov_b32 v19, 122880
    ds_read_b32 v63, v19
    s_waitcnt lgkmcnt(0)
    v_readfirstlane_b32 s63, v63
    s_cmp_ge_u32 s46, 2
    s_cbranch_scc1 K1_NN3
    v_lshlrev_b32 v5, 4, v2
    s_mov_b32 exec_hi, 0
    buffer_store_dwordx4 v[60:63], v5, s[16:19], s62 offen sc1
    s_mov_b32 exec_hi, -1
K1_NN3:
    s_sub_u32 s47, s47, 1
    s_cmp_lg_u32 s47, 0
    s_cbranch_scc1 K1_LM
    s_waitcnt vmcnt(10)
    s_barrier
    s_cmp_ge_u32 s46, 2
    s_cbranch_scc1 K1_GCOL
    s_lshl_b32 s60, s46, 6
    v_add_u32 v3, s60, v2
    s_lshl_b32 s60, s4, 7
    v_add_u32 v4, s60, v3
    v_lshlrev_b32 v4, 4, v4
    s_mov_b32 s60, 7770112
    buffer_load_dwordx4 v[24:27], v4, s[16:19], s60 offen sc1
    s_mov_b32 s88, s84
    s_and_b32 s89, s85, 0xffff
    s_mov_b32 s90, 1409024
    s_mov_b32 s91, 0x20000
    s_mov_b32 s76, s82
    s_and_b32 s77, s83, 0xffff
    s_mov_b32 s78, 524288
    s_mov_b32 s79, 0x20000
    s_lshr_b32 s80, s2, 3
    s_mul_i32 s81, s80, 44032
    s_mul_i32 s86, s46, 11008
    s_add_u32 s81, s81, s86
    v_lshlrev_b32 v8, 7, v2
    buffer_load_dword v120, v8, s[88:91], s81 offen
    s_add_u32 s81, s81, 8192
    s_mov_b32 exec_lo, 0x3fffff
    s_mov_b32 exec_hi, 0
    buffer_load_dword v120, v8, s[88:91], s81 offen
    s_lshl_b32 s81, s80, 14
    s_lshl_b32 s86, s46, 12
    s_add_u32 s81, s81, s86
    s_mov_b32 exec_lo, -1
    buffer_load_dword v120, v8, s[76:79], s81 offen
    s_mov_b64 exec, -1
    s_waitcnt vmcnt(4)
    s_barrier
    s_mov_b32 s61, 0x40000
    s_waitcnt vmcnt(3)
K1_GR:
    v_cmp_ne_u32 vcc, s63, v26
    s_sub_u32 s61, s61, 1
    s_cmp_eq_u32 s61, 0
    s_cbranch_scc1 K1_GRD
    s_cbranch_vccz K1_GRD
    s_sleep 1
    buffer_load_dwordx4 v[24:27], v4, s[16:19], s60 offen sc1
    s_waitcnt vmcnt(0)
    s_branch K1_GR
K1_GRD:
    v_rsq_f32 v44, v25
    v_cvt_pk_bf16_f32 v40, v24, v24
    v_mul_f32 v45, v25, v44
    v_lshlrev_b32 v40, 16, v40
    v_sub_f32 v41, v24, v40
    v_cvt_pk_bf16_f32 v40, v40, v41
    v_mov_b32 v41, v40
    v_cvt_pk_bf16_f32 v42, v45, v45
    v_lshlrev_b32 v42, 16, v42
    v_sub_f32 v43, v45, v42
    v_cvt_pk_bf16_f32 v42, v42, v43
    v_mov_b32 v43, 0
    v_mul_f32 v46, v44, v44
    v_mul_f32 v46, v46, v44
    v_mul_f32 v46, 0xbdd2d3e8, v46
    v_mul_f32 v47, 0xc0135761, v44
    v_lshlrev_b32 v4, 5, v3
    v_add_u32 v4, 123904, v4
    ds_write_b128 v4, v[40:43]
    ds_write_b128 v4, v[44:47] offset:16
    v_lshlrev_b32 v4, 2, v3
    v_add_u32 v4, 128000, v4
    ds_write_b32 v4, v44
    v_mov_b32 v4, 122896
    v_mov_b32 v40, 0
    v_mov_b32 v41, 0
    v_mov_b32 v42, 0
    ds_write_b128 v4, v[40:43]
    s_branch K1_GDONE
K1_GCOL:
    s_and_b32 s47, s46, 1
    v_and_b32 v3, 31, v2
    v_lshrrev_b32 v4, 5, v2
    v_lshlrev_b32 v4, 13, v4
    v_lshl_add_u32 v4, v3, 4, v4
    s_lshl_b32 s60, s5, 14
    s_lshl_b32 s61, s47, 9
    s_add_u32 s60, s60, s61
    s_add_u32 s60, s60, 7802880
    s_mul_i32 s61, s47, 3
    s_add_u32 s61, s61, s44
    s_lshl_b32 s61, s61, 6
    v_lshl_add_u32 v5, v3, 1, s61
    buffer_load_ushort v60, v5, s[20:23], 0 offen
    buffer_load_ushort v61, v5, s[20:23], 0 offen offset:64
    buffer_load_ushort v62, v5, s[20:23], 0 offen offset:128
    s_add_u32 s62, s60, 4096
    buffer_load_dwordx4 v[24:27], v4, s[16:19], s60 offen offset:0 sc1
    buffer_load_dwordx4 v[28:31], v4, s[16:19], s60 offen offset:1024 sc1
    buffer_load_dwordx4 v[32:35], v4, s[16:19], s60 offen offset:2048 sc1
    buffer_load_dwordx4 v[36:39], v4, s[16:19], s60 offen offset:3072 sc1
    buffer_load_dwordx4 v[40:43], v4, s[16:19], s62 offen offset:0 sc1
    buffer_load_dwordx4 v[44:47], v4, s[16:19], s62 offen offset:1024 sc1
    buffer_load_dwordx4 v[48:51], v4, s[16:19], s62 offen offset:2048 sc1
    buffer_load_dwordx4 v[52:55], v4, s[16:19], s62 offen offset:3072 sc1
    s_mov_b32 s88, s84
    s_and_b32 s89, s85, 0xffff
    s_mov_b32 s90, 1409024
    s_mov_b32 s91, 0x20000
    s_mov_b32 s76, s82
    s_and_b32 s77, s83, 0xffff
    s_mov_b32 s78, 524288
    s_mov_b32 s79, 0x20000
    s_lshr_b32 s80, s2, 3
    s_mul_i32 s81, s80, 44032
    s_mul_i32 s86, s46, 11008
    s_add_u32 s81, s81, s86
    v_lshlrev_b32 v8, 7, v2
    buffer_load_dword v120, v8, s[88:91], s81 offen
    s_add_u32 s81, s81, 8192
    s_mov_b32 exec_lo, 0x3fffff
    s_mov_b32 exec_hi, 0
    buffer_load_dword v120, v8, s[88:91], s81 offen
    s_lshl_b32 s81, s80, 14
    s_lshl_b32 s86, s46, 12
    s_add_u32 s81, s81, s86
    s_mov_b32 exec_lo, -1
    buffer_load_dword v120, v8, s[76:79], s81 offen
    s_mov_b64 exec, -1
    s_waitcnt vmcnt(14)
    s_barrier
    s_mov_b32 s61, 0x40000
    s_waitcnt vmcnt(3)
K1_GC:
    v_xor_b32 v6, s63, v27
    v_xor_b32 v7, s63, v31
    v_or_b32 v6, v6, v7
    v_xor_b32 v7, s63, v35
    v_or_b32 v6, v6, v7
    v_xor_b32 v7, s63, v39
    v_or_b32 v6, v6, v7
    v_xor_b32 v7, s63, v43
    v_or_b32 v6, v6, v7
    v_xor_b32 v7, s63, v47
    v_or_b32 v6, v6, v7
    v_xor_b32 v7, s63, v51
    v_or_b32 v6, v6, v7
    v_xor_b32 v7, s63, v55
    v_or_b32 v6, v6, v7
    v_cmp_ne_u32 vcc, 0, v6
    s_sub_u32 s61, s61, 1
    s_cmp_eq_u32 s61, 0
    s_cbranch_scc1 K1_GCD
    s_cbranch_vccz K1_GCD
    s_sleep 1
    buffer_load_dwordx4 v[24:27], v4, s[16:19], s60 offen offset:0 sc1
    buffer_load_dwordx4 v[28:31], v4, s[16:19], s60 offen offset:1024 sc1
    buffer_load_dwordx4 v[32:35], v4, s[16:19], s60 offen offset:2048 sc1
    buffer_load_dwordx4 v[36:39], v4, s[16:19], s60 offen offset:3072 sc1
    buffer_load_dwordx4 v[40:43], v4, s[16:19], s62 offen offset:0 sc1
    buffer_load_dwordx4 v[44:47], v4, s[16:19], s62 offen offset:1024 sc1
    buffer_load_dwordx4 v[48:51], v4, s[16:19], s62 offen offset:2048 sc1
    buffer_load_dwordx4 v[52:55], v4, s[16:19], s62 offen offset:3072 sc1
    s_waitcnt vmcnt(0)
    s_branch K1_GC
K1_GCD:
    v_add_f32 v24, v24, v28
    v_add_f32 v32, v32, v36
    v_add_f32 v40, v40, v44
    v_add_f32 v48, v48, v52
    v_add_f32 v24, v24, v32
    v_add_f32 v40, v40, v48
    v_add_f32 v24, v24, v40
    v_mov_b32 v28, v24
    v_add_f32 v25, v25, v29
    v_add_f32 v33, v33, v37
    v_add_f32 v41, v41, v45
    v_add_f32 v49, v49, v53
    v_add_f32 v25, v25, v33
    v_add_f32 v41, v41, v49
    v_add_f32 v25, v25, v41
    v_mov_b32 v29, v25
    v_add_f32 v26, v26, v30
    v_add_f32 v34, v34, v38
    v_add_f32 v42, v42, v46
    v_add_f32 v50, v50, v54
    v_add_f32 v26, v26, v34
    v_add_f32 v42, v42, v50
    v_add_f32 v26, v26, v42
    v_mov_b32 v30, v26
    s_nop 1
    v_permlane32_swap_b32 v24, v28
    v_permlane32_swap_b32 v25, v29
    v_permlane32_swap_b32 v26, v30
    s_mul_i32 s61, s47, 1536
    s_add_u32 s61, s61, 128512
    v_lshl_add_u32 v5, v3, 4, s61
    v_add_f32 v8, v24, v28
    v_cvt_pk_bf16_f32 v40, v8, v8
    v_lshlrev_b32 v9, 16, v40
    v_sub_f32 v9, v8, v9
    v_cvt_pk_bf16_f32 v41, v9, v9
    v_lshlrev_b32 v42, 16, v60
    v_or_b32 v42, v42, v60
    v_mov_b32 v43, 0
    s_cmp_eq_u32 s7, 0
    s_cbranch_scc0 K1_GB0
    v_mov_b32 v42, 0
K1_GB0:
    ds_write_b128 v5, v[40:43] offset:0
    s_nop 1
    v_add_f32 v8, v25, v29
    v_cvt_pk_bf16_f32 v40, v8, v8
    v_lshlrev_b32 v9, 16, v40
    v_sub_f32 v9, v8, v9
    v_cvt_pk_bf16_f32 v41, v9, v9
    v_lshlrev_b32 v42, 16, v61
    v_or_b32 v42, v42, v61
    v_mov_b32 v43, 0
    s_cmp_eq_u32 s7, 0
    s_cbranch_scc0 K1_GB1
    v_mov_b32 v42, 0
K1_GB1:
    ds_write_b128 v5, v[40:43] offset:512
    s_nop 1
    v_add_f32 v8, v26, v30
    v_cvt_pk_bf16_f32 v40, v8, v8
    v_lshlrev_b32 v9, 16, v40
    v_sub_f32 v9, v8, v9
    v_cvt_pk_bf16_f32 v41, v9, v9
    v_lshlrev_b32 v42, 16, v62
    v_or_b32 v42, v42, v62
    v_mov_b32 v43, 0
    s_cmp_eq_u32 s7, 0
    s_cbranch_scc0 K1_GB2
    v_mov_b32 v42, 0
K1_GB2:
    ds_write_b128 v5, v[40:43] offset:1024
    s_nop 1
K1_GDONE:
K1_PFW:
K1_LE1:
    s_waitcnt lgkmcnt(0)
    s_barrier
    s_lshl_b32 s87, s4, 4
    s_add_u32 s87, s87, s5
    s_lshl_b32 s87, s87, 2
    s_add_u32 s87, s87, 8065024
    s_branch K2_LENTRY
K1_CONS:
    s_and_b32 s46, s3, 1
    s_lshr_b32 s47, s3, 1
    s_lshl_b32 s48, s4, 7
    s_lshl_b32 s49, s5, 3
    s_add_u32 s48, s48, s49
    s_lshl_b32 s49, s3, 1
    s_add_u32 s57, s48, s49
    s_lshl_b32 s48, s57, 10
    v_lshlrev_b32 v10, 4, v2
    s_waitcnt lgkmcnt(0)
    s_mov_b32 s8, s28
    s_and_b32 s9, s29, 0xffff
    s_mov_b32 s10, 2097152
    s_mov_b32 s11, 0x20000
    s_mov_b32 s58, s48
    s_mov_b32 s16, s38
    s_and_b32 s17, s39, 0xffff
    s_mov_b32 s18, 8072192
    s_mov_b32 s19, 0x20000
    s_mov_b32 s24, s36
    s_and_b32 s25, s37, 0xffff
    s_mov_b32 s26, 256
    s_mov_b32 s27, 0x20000
    s_cmp_lg_u32 s3, 0
    s_cbranch_scc1 K1_NOZ
    s_cmp_lg_u32 s2, 0
    s_cbranch_scc1 K1_NON
    s_memrealtime s[48:49]
    s_waitcnt lgkmcnt(0)
    s_or_b32 s48, s48, 1
    v_mov_b32 v5, s48
    v_mov_b32 v4, 192
    s_mov_b64 exec, 1
    buffer_store_dword v5, v4, s[24:27], 0 offen sc1
    s_mov_b64 exec, -1
K1_NON:
    s_cmp_lg_u32 s7, 0
    s_cbranch_scc1 K1_NOZ
    s_cmp_lg_u32 s4, 0
    s_cbranch_scc1 K1_NOZ
    v_mov_b32 v12, 0
    v_mov_b32 v13, 0
    v_mov_b32 v14, 0
    v_mov_b32 v15, 0
    s_lshl_b32 s48, s5, 12
    s_add_u32 s48, s48, 7733248
    buffer_store_dwordx4 v[12:15], v10, s[16:19], s48 offen sc1
    buffer_store_dwordx4 v[12:15], v10, s[16:19], s48 offen offset:1024 sc1
    buffer_store_dwordx4 v[12:15], v10, s[16:19], s48 offen offset:2048 sc1
    buffer_store_dwordx4 v[12:15], v10, s[16:19], s48 offen offset:3072 sc1
    s_mov_b32 exec_lo, 0xffff
    s_mov_b32 exec_hi, 0
    s_lshl_b32 s48, s5, 8
    s_add_u32 s48, s48, 7766016
    buffer_store_dwordx4 v[12:15], v10, s[16:19], s48 offen sc1
    s_waitcnt vmcnt(0)
    s_mov_b32 exec_lo, 1
    v_mov_b32 v5, 1
    s_lshl_b32 s48, s5, 2
    v_mov_b32 v4, s48
    buffer_store_dword v5, v4, s[24:27], 0 offen sc1
    s_mov_b64 exec, -1
K1_NOZ:
    v_and_b32 v3, 31, v2
    v_lshrrev_b32 v4, 5, v2
    v_lshrrev_b32 v5, 1, v3
    v_and_b32 v5, 7, v5
    v_xor_b32 v5, v5, v4
    v_lshlrev_b32 v5, 4, v5
    v_lshl_add_u32 v5, v3, 7, v5
    s_lshl_b32 s49, s46, 13
    v_add_u32 v5, s49, v5
    s_lshl_b32 s49, s46, 5
    v_xor_b32 v104, s49, v5
    v_xor_b32 v105, 32, v5
    v_xor_b32 v105, s49, v105
    v_xor_b32 v106, 64, v104
    v_xor_b32 v107, 64, v105
    v_lshrrev_b32 v4, 5, v2
    v_and_b32 v6, 15, v2
    v_lshrrev_b32 v6, 2, v6
    v_lshl_add_u32 v6, v4, 3, v6
    v_lshlrev_b32 v6, 7, v6
    v_and_b32 v7, 3, v2
    v_lshlrev_b32 v7, 3, v7
    v_bfe_u32 v8, v2, 4, 1
    v_lshl_add_u32 v7, v8, 5, v7
    v_bfe_u32 v8, v2, 3, 1
    v_lshlrev_b32 v8, 6, v8
    s_mul_i32 s50, s47, 3
    s_add_u32 s50, s50, 0
    s_lshr_b32 s51, s50, 1
    s_and_b32 s50, s50, 1
    s_cmp_eq_u32 s7, 0
    s_cselect_b32 s51, 0, s51
    s_cselect_b32 s50, s47, s50
    s_lshl_b32 s51, s51, 13
    s_add_u32 s51, s51, 16384
    s_lshl_b32 s50, s50, 6
    v_add_u32 v9, s50, v7
    v_xor_b32 v9, v9, v8
    v_add3_u32 v108, v9, v6, s51
    s_mul_i32 s50, s47, 3
    s_add_u32 s50, s50, 1
    s_lshr_b32 s51, s50, 1
    s_and_b32 s50, s50, 1
    s_cmp_eq_u32 s7, 0
    s_cselect_b32 s51, 1, s51
    s_cselect_b32 s50, s47, s50
    s_lshl_b32 s51, s51, 13
    s_add_u32 s51, s51, 16384
    s_lshl_b32 s50, s50, 6
    v_add_u32 v9, s50, v7
    v_xor_b32 v9, v9, v8
    v_add3_u32 v109, v9, v6, s51
    s_mul_i32 s50, s47, 3
    s_add_u32 s50, s50, 2
    s_lshr_b32 s51, s50, 1
    s_and_b32 s50, s50, 1
    s_cmp_eq_u32 s7, 0
    s_cselect_b32 s51, 2, s51
    s_cselect_b32 s50, s47, s50
    s_lshl_b32 s51, s51, 13
    s_add_u32 s51, s51, 16384
    s_lshl_b32 s50, s50, 6
    v_add_u32 v9, s50, v7
    v_xor_b32 v9, v9, v8
    v_add3_u32 v110, v9, v6, s51
    v_mov_b32 v128, 0
    v_mov_b32 v129, 0
    v_mov_b32 v130, 0
    v_mov_b32 v131, 0
    v_mov_b32 v132, 0
    v_mov_b32 v133, 0
    v_mov_b32 v134, 0
    v_mov_b32 v135, 0
    v_mov_b32 v136, 0
    v_mov_b32 v137, 0
    v_mov_b32 v138, 0
    v_mov_b32 v139, 0
    v_mov_b32 v140, 0
    v_mov_b32 v141, 0
    v_mov_b32 v142, 0
    v_mov_b32 v143, 0
    v_mov_b32 v144, 0
    v_mov_b32 v145, 0
    v_mov_b32 v146, 0
    v_mov_b32 v147, 0
    v_mov_b32 v148, 0
    v_mov_b32 v149, 0
    v_mov_b32 v150, 0
    v_mov_b32 v151, 0
    v_mov_b32 v152, 0
    v_mov_b32 v153, 0
    v_mov_b32 v154, 0
    v_mov_b32 v155, 0
    v_mov_b32 v156, 0
    v_mov_b32 v157, 0
    v_mov_b32 v158, 0
    v_mov_b32 v159, 0
    v_mov_b32 v160, 0
    v_mov_b32 v161, 0
    v_mov_b32 v162, 0
    v_mov_b32 v163, 0
    v_mov_b32 v164, 0
    v_mov_b32 v165, 0
    v_mov_b32 v166, 0
    v_mov_b32 v167, 0
    v_mov_b32 v168, 0
    v_mov_b32 v169, 0
    v_mov_b32 v170, 0
    v_mov_b32 v171, 0
    v_mov_b32 v172, 0
    v_mov_b32 v173, 0
    v_mov_b32 v174, 0
    v_mov_b32 v175, 0
    v_mov_b32 v176, 0
    v_mov_b32 v177, 0
    v_mov_b32 v178, 0
    v_mov_b32 v179, 0
    v_mov_b32 v180, 0
    v_mov_b32 v181, 0
    v_mov_b32 v182, 0
    v_mov_b32 v183, 0
    v_mov_b32 v184, 0
    v_mov_b32 v185, 0
    v_mov_b32 v186, 0
    v_mov_b32 v187, 0
    v_mov_b32 v188, 0
    v_mov_b32 v189, 0
    v_mov_b32 v190, 0
    v_mov_b32 v191, 0
    v_mov_b32 v192, 0
    v_mov_b32 v193, 0
    v_mov_b32 v194, 0
    v_mov_b32 v195, 0
    v_mov_b32 v196, 0
    v_mov_b32 v197, 0
    v_mov_b32 v198, 0
    v_mov_b32 v199, 0
    v_mov_b32 v200, 0
    v_mov_b32 v201, 0
    v_mov_b32 v202, 0
    v_mov_b32 v203, 0
    v_mov_b32 v204, 0
    v_mov_b32 v205, 0
    v_mov_b32 v206, 0
    v_mov_b32 v207, 0
    v_mov_b32 v208, 0
    v_mov_b32 v209, 0
    v_mov_b32 v210, 0
    v_mov_b32 v211, 0
    v_mov_b32 v212, 0
    v_mov_b32 v213, 0
    v_mov_b32 v214, 0
    v_mov_b32 v215, 0
    v_mov_b32 v216, 0
    v_mov_b32 v217, 0
    v_mov_b32 v218, 0
    v_mov_b32 v219, 0
    v_mov_b32 v220, 0
    v_mov_b32 v221, 0
    v_mov_b32 v222, 0
    v_mov_b32 v223, 0
    v_mov_b32 v84, 0
    v_mov_b32 v85, 0
    v_mov_b32 v86, 0
    v_mov_b32 v87, 0
    v_mov_b32 v88, 0
    v_mov_b32 v89, 0
    v_mov_b32 v90, 0
    v_mov_b32 v91, 0
    v_mov_b32 v92, 0
    v_mov_b32 v93, 0
    v_mov_b32 v94, 0
    v_mov_b32 v95, 0
    v_mov_b32 v96, 0
    v_mov_b32 v97, 0
    v_mov_b32 v98, 0
    v_mov_b32 v99, 0
    v_mov_b32 v100, 0
    v_mov_b32 v101, 0
    v_mov_b32 v102, 0
    v_mov_b32 v103, 0
    v_lshlrev_b32 v10, 4, v2
    buffer_load_dwordx4 v[16:19], v10, s[8:11], s58 offen
    buffer_load_dwordx4 v[20:23], v10, s[8:11], s58 offen offset:1024
    s_lshl_b32 s56, s57, 4
    s_add_u32 s56, s56, 7770112
    s_lshl_b32 s50, s46, 11
    v_subrev_u32 v113, s50, v110
    v_add_u32 v112, s50, v110
    v_subrev_u32 v111, s50, v109
    v_add_u32 v110, s50, v109
    v_subrev_u32 v109, s50, v108
    v_add_u32 v108, s50, v108
    s_mov_b32 s48, 8
    s_mov_b32 s49, 0
    s_setprio 3
    s_cmp_lg_u32 s7, 0
    s_cbranch_scc1 K1_CF
K1_MLQ:
    s_barrier
    v_mfma_f32_32x32x16_bf16 v[128:143], v[92:95], v[84:87], v[128:143]
    ds_read_b128 v[64:67], v104
    ds_read_b64_tr_b16 v[72:73], v108 offset:0
    ds_read_b64_tr_b16 v[74:75], v108 offset:512
    v_mfma_f32_32x32x16_bf16 v[144:159], v[92:95], v[88:91], v[144:159]
    ds_read_b128 v[68:71], v104 offset:4096
    ds_read_b64_tr_b16 v[76:77], v110 offset:0
    ds_read_b64_tr_b16 v[78:79], v110 offset:512
    v_mfma_f32_32x32x16_bf16 v[160:175], v[84:87], v[96:99], v[160:175]
    ds_read_b64_tr_b16 v[80:81], v112 offset:0
    ds_read_b64_tr_b16 v[82:83], v112 offset:512
    v_mfma_f32_32x32x16_bf16 v[176:191], v[88:91], v[96:99], v[176:191]
    v_mfma_f32_32x32x16_bf16 v[192:207], v[84:87], v[100:103], v[192:207]
    v_mfma_f32_32x32x16_bf16 v[208:223], v[88:91], v[100:103], v[208:223]
    s_waitcnt lgkmcnt(5)
    v_mfma_f32_32x32x16_bf16 v[128:143], v[72:75], v[64:67], v[128:143]
    ds_read_b128 v[84:87], v105
    ds_read_b64_tr_b16 v[92:93], v109 offset:2048
    ds_read_b64_tr_b16 v[94:95], v109 offset:2560
    s_waitcnt lgkmcnt(7)
    v_mfma_f32_32x32x16_bf16 v[144:159], v[72:75], v[68:71], v[144:159]
    ds_read_b128 v[88:91], v105 offset:4096
    ds_read_b64_tr_b16 v[96:97], v111 offset:2048
    ds_read_b64_tr_b16 v[98:99], v111 offset:2560
    s_waitcnt lgkmcnt(8)
    v_mfma_f32_32x32x16_bf16 v[160:175], v[64:67], v[76:79], v[160:175]
    ds_read_b64_tr_b16 v[100:101], v113 offset:2048
    ds_read_b64_tr_b16 v[102:103], v113 offset:2560
    v_mfma_f32_32x32x16_bf16 v[176:191], v[68:71], v[76:79], v[176:191]
    s_waitcnt lgkmcnt(8)
    v_mfma_f32_32x32x16_bf16 v[192:207], v[64:67], v[80:83], v[192:207]
    v_mfma_f32_32x32x16_bf16 v[208:223], v[68:71], v[80:83], v[208:223]
    s_waitcnt lgkmcnt(5)
    v_mfma_f32_32x32x16_bf16 v[128:143], v[92:95], v[84:87], v[128:143]
    ds_read_b128 v[64:67], v106
    ds_read_b64_tr_b16 v[72:73], v108 offset:4096
    ds_read_b64_tr_b16 v[74:75], v108 offset:4608
    s_waitcnt lgkmcnt(7)
    v_mfma_f32_32x32x16_bf16 v[144:159], v[92:95], v[88:91], v[144:159]
    ds_read_b128 v[68:71], v106 offset:4096
    ds_read_b64_tr_b16 v[76:77], v110 offset:4096
    ds_read_b64_tr_b16 v[78:79], v110 offset:4608
    s_waitcnt lgkmcnt(8)
    v_mfma_f32_32x32x16_bf16 v[160:175], v[84:87], v[96:99], v[160:175]
    ds_read_b64_tr_b16 v[80:81], v112 offset:4096
    ds_read_b64_tr_b16 v[82:83], v112 offset:4608
    v_mfma_f32_32x32x16_bf16 v[176:191], v[88:91], v[96:99], v[176:191]
    s_waitcnt lgkmcnt(8)
    v_mfma_f32_32x32x16_bf16 v[192:207], v[84:87], v[100:103], v[192:207]
    v_mfma_f32_32x32x16_bf16 v[208:223], v[88:91], v[100:103], v[208:223]
    s_waitcnt lgkmcnt(5)
    v_mfma_f32_32x32x16_bf16 v[128:143], v[72:75], v[64:67], v[128:143]
    ds_read_b128 v[84:87], v107
    ds_read_b64_tr_b16 v[92:93], v109 offset:6144
    ds_read_b64_tr_b16 v[94:95], v109 offset:6656
    s_waitcnt lgkmcnt(7)
    v_mfma_f32_32x32x16_bf16 v[144:159], v[72:75], v[68:71], v[144:159]
    ds_read_b128 v[88:91], v107 offset:4096
    ds_read_b64_tr_b16 v[96:97], v111 offset:6144
    ds_read_b64_tr_b16 v[98:99], v111 offset:6656
    s_waitcnt lgkmcnt(8)
    v_mfma_f32_32x32x16_bf16 v[160:175], v[64:67], v[76:79], v[160:175]
    ds_read_b64_tr_b16 v[100:101], v113 offset:6144
    ds_read_b64_tr_b16 v[102:103], v113 offset:6656
    v_mfma_f32_32x32x16_bf16 v[176:191], v[68:71], v[76:79], v[176:191]
    s_add_u32 s49, s49, s64
    s_cmp_eq_u32 s49, 122880
    s_cselect_b32 s50, s65, s64
    s_cselect_b32 s49, 0, s49
    s_waitcnt lgkmcnt(8)
    v_mfma_f32_32x32x16_bf16 v[192:207], v[64:67], v[80:83], v[192:207]
    v_add_u32 v104, s50, v104
    v_add_u32 v105, s50, v105
    v_add_u32 v106, s50, v106
    v_add_u32 v107, s50, v107
    v_add_u32 v108, s50, v108
    v_mfma_f32_32x32x16_bf16 v[208:223], v[68:71], v[80:83], v[208:223]
    v_add_u32 v109, s50, v109
    v_add_u32 v110, s50, v110
    v_add_u32 v111, s50, v111
    v_add_u32 v112, s50, v112
    v_add_u32 v113, s50, v113
    s_waitcnt lgkmcnt(0)
    s_cmp_lg_u32 s48, 8
    s_cbranch_scc1 K1_NSTQ
    v_mov_b32 v12, 0x3f803f80
    v_mov_b32 v24, 0
    v_mov_b32 v26, 0
    v_mov_b32 v28, 0
    v_mov_b32 v30, 0
    s_waitcnt vmcnt(0)
    v_dot2_f32_bf16 v24, v16, v12, v24
    v_dot2_f32_bf16 v26, v16, v16, v26
    v_dot2_f32_bf16 v28, v20, v12, v28
    v_dot2_f32_bf16 v30, v20, v20, v30
    v_dot2_f32_bf16 v24, v17, v12, v24
    v_dot2_f32_bf16 v26, v17, v17, v26
    v_dot2_f32_bf16 v28, v21, v12, v28
    v_dot2_f32_bf16 v30, v21, v21, v30
    v_dot2_f32_bf16 v24, v18, v12, v24
    v_dot2_f32_bf16 v26, v18, v18, v26
    v_dot2_f32_bf16 v28, v22, v12, v28
    v_dot2_f32_bf16 v30, v22, v22, v30
    v_dot2_f32_bf16 v24, v19, v12, v24
    v_dot2_f32_bf16 v26, v19, v19, v26
    v_dot2_f32_bf16 v28, v23, v12, v28
    v_dot2_f32_bf16 v30, v23, v23, v30
    s_nop 2
    v_add_f32_dpp v24, v24, v24 row_shr:1 row_mask:0xf bank_mask:0xf bound_ctrl:0
    v_add_f32_dpp v26, v26, v26 row_shr:1 row_mask:0xf bank_mask:0xf bound_ctrl:0
    v_add_f32_dpp v28, v28, v28 row_shr:1 row_mask:0xf bank_mask:0xf bound_ctrl:0
    v_add_f32_dpp v30, v30, v30 row_shr:1 row_mask:0xf bank_mask:0xf bound_ctrl:0
    v_add_f32_dpp v24, v24, v24 row_shr:2 row_mask:0xf bank_mask:0xf bound_ctrl:0
    v_add_f32_dpp v26, v26, v26 row_shr:2 row_mask:0xf bank_mask:0xf bound_ctrl:0
    v_add_f32_dpp v28, v28, v28 row_shr:2 row_mask:0xf bank_mask:0xf bound_ctrl:0
    v_add_f32_dpp v30, v30, v30 row_shr:2 row_mask:0xf bank_mask:0xf bound_ctrl:0
    v_add_f32_dpp v24, v24, v24 row_shr:4 row_mask:0xf bank_mask:0xf bound_ctrl:0
    v_add_f32_dpp v26, v26, v26 row_shr:4 row_mask:0xf bank_mask:0xf bound_ctrl:0
    v_add_f32_dpp v28, v28, v28 row_shr:4 row_mask:0xf bank_mask:0xf bound_ctrl:0
    v_add_f32_dpp v30, v30, v30 row_shr:4 row_mask:0xf bank_mask:0xf bound_ctrl:0
    v_add_f32_dpp v24, v24, v24 row_shr:8 row_mask:0xf bank_mask:0xf bound_ctrl:0
    v_add_f32_dpp v26, v26, v26 row_shr:8 row_mask:0xf bank_mask:0xf bound_ctrl:0
    v_add_f32_dpp v28, v28, v28 row_shr:8 row_mask:0xf bank_mask:0xf bound_ctrl:0
    v_add_f32_dpp v30, v30, v30 row_shr:8 row_mask:0xf bank_mask:0xf bound_ctrl:0
    v_add_f32_dpp v24, v24, v24 row_bcast:15 row_mask:0xa bank_mask:0xf
    v_add_f32_dpp v26, v26, v26 row_bcast:15 row_mask:0xa bank_mask:0xf
    v_add_f32_dpp v28, v28, v28 row_bcast:15 row_mask:0xa bank_mask:0xf
    v_add_f32_dpp v30, v30, v30 row_bcast:15 row_mask:0xa bank_mask:0xf
    v_add_f32_dpp v24, v24, v24 row_bcast:31 row_mask:0xc bank_mask:0xf
    v_add_f32_dpp v26, v26, v26 row_bcast:31 row_mask:0xc bank_mask:0xf
    v_add_f32_dpp v28, v28, v28 row_bcast:31 row_mask:0xc bank_mask:0xf
    v_add_f32_dpp v30, v30, v30 row_bcast:31 row_mask:0xc bank_mask:0xf
    v_mul_f32 v32, 0xbb000000, v24
    v_mul_f32 v33, 0x3b000000, v26
    v_fma_f32 v33, -v32, v32, v33
    v_max_f32 v33, 0, v33
    v_add_f32 v33, 0x3727c5ac, v33
    v_mul_f32 v36, 0xbb000000, v28
    v_mul_f32 v37, 0x3b000000, v30
    v_fma_f32 v37, -v36, v36, v37
    v_max_f32 v37, 0, v37
    v_add_f32 v37, 0x3727c5ac, v37
K1_NSTQ:
    s_cmp_lg_u32 s48, 7
    s_cbranch_scc1 K1_NPUBQ
    v_mov_b32 v4, 122880
    ds_read_b32 v34, v4
    v_mov_b32 v4, 0
    s_waitcnt lgkmcnt(0)
    v_readfirstlane_b32 s59, v34
    v_mov_b32 v35, v34
    v_mov_b32 v38, v34
    v_mov_b32 v39, v34
    s_mov_b32 exec_lo, 0
    s_mov_b32 exec_hi, 0x80000000
    buffer_store_dwordx4 v[32:35], v4, s[16:19], s56 offen sc1
    buffer_store_dwordx4 v[36:39], v4, s[16:19], s56 offen offset:16 sc1
    s_mov_b64 exec, -1
K1_NPUBQ:
    s_sub_u32 s48, s48, 1
    s_cmp_lg_u32 s48, 0
    s_cbranch_scc1 K1_MLQ
    v_mfma_f32_32x32x16_bf16 v[128:143], v[92:95], v[84:87], v[128:143]
    v_mfma_f32_32x32x16_bf16 v[144:159], v[92:95], v[88:91], v[144:159]
    v_mfma_f32_32x32x16_bf16 v[160:175], v[84:87], v[96:99], v[160:175]
    v_mfma_f32_32x32x16_bf16 v[176:191], v[88:91], v[96:99], v[176:191]
    v_mfma_f32_32x32x16_bf16 v[192:207], v[84:87], v[100:103], v[192:207]
    v_mfma_f32_32x32x16_bf16 v[208:223], v[88:91], v[100:103], v[208:223]
    v_and_b32 v3, 31, v2
    s_lshl_b32 s48, s46, 6
    v_add_u32 v4, s48, v3
    v_lshlrev_b32 v4, 5, v4
    v_add_u32 v4, 123904, v4
    v_mov_b32 v5, 122896
    v_cmp_gt_u32 vcc, 32, v2
    s_mul_i32 s49, s47, 1536
    s_add_u32 s49, s49, 128512
    v_lshl_add_u32 v6, v3, 4, s49
    v_cndmask_b32 v5, v5, v4, vcc
    v_add_u32 v7, 1024, v4
    v_mov_b32 v8, 122896
    v_cndmask_b32 v7, v8, v7, vcc
    s_barrier
    ds_read_b128 v[80:83], v6
    ds_read_b128 v[64:67], v5
    ds_read_b128 v[68:71], v7
    ds_read_b128 v[84:87], v6 offset:512
    ds_read_b128 v[88:91], v6 offset:1024
    ds_read_b128 v[72:75], v4 offset:16
    ds_read_b128 v[76:79], v4 offset:1040
    s_waitcnt lgkmcnt(5)
    v_mfma_f32_32x32x16_bf16 v[128:143], v[80:83], v[64:67], v[128:143]
    s_waitcnt lgkmcnt(4)
    v_mfma_f32_32x32x16_bf16 v[144:159], v[80:83], v[68:71], v[144:159]
    s_waitcnt lgkmcnt(3)
    v_mfma_f32_32x32x16_bf16 v[160:175], v[64:67], v[84:87], v[160:175]
    v_mfma_f32_32x32x16_bf16 v[176:191], v[68:71], v[84:87], v[176:191]
    s_waitcnt lgkmcnt(2)
    v_mfma_f32_32x32x16_bf16 v[192:207], v[64:67], v[88:91], v[192:207]
    v_mfma_f32_32x32x16_bf16 v[208:223], v[68:71], v[88:91], v[208:223]
    s_waitcnt lgkmcnt(0)
    v_lshlrev_b32 v4, 4, v2
    s_lshl_b32 s48, s4, 2
    s_lshl_b32 s49, s46, 1
    s_add_u32 s48, s48, s49
    s_lshl_b32 s48, s48, 5
    s_lshl_b32 s49, s5, 2
    s_lshl_b32 s50, s47, 1
    s_add_u32 s49, s49, s50
    s_add_u32 s48, s48, s49
    s_lshl_b32 s48, s48, 10
    s_add_u32 s48, s48, 5636096
    s_add_u32 s51, s48, 32768
    v_lshrrev_b32 v5, 5, v2
    v_lshlrev_b32 v5, 4, v5
    s_lshl_b32 s49, s46, 8
    s_add_u32 s49, s49, 128000
    v_add_u32 v5, s49, v5
    v_mov_b32 v116, 0x3fb8aa3b
    v_mov_b32 v118, 0x358637bd
    v_mul_f32 v6, v116, v72
    v_mul_f32 v24, v116, v76
    ds_read_b128 v[48:51], v5 offset:0
    ds_read_b128 v[52:55], v5 offset:32
    ds_read_b128 v[56:59], v5 offset:64
    ds_read_b128 v[60:63], v5 offset:96
    v_pk_mul_f32 v[8:9], v[128:129], v[6:7] op_sel_hi:[1,0]
    v_pk_mul_f32 v[10:11], v[130:131], v[6:7] op_sel_hi:[1,0]
    v_pk_mul_f32 v[12:13], v[132:133], v[6:7] op_sel_hi:[1,0]
    v_pk_mul_f32 v[14:15], v[134:135], v[6:7] op_sel_hi:[1,0]
    v_pk_mul_f32 v[16:17], v[136:137], v[6:7] op_sel_hi:[1,0]
    v_pk_mul_f32 v[18:19], v[138:139], v[6:7] op_sel_hi:[1,0]
    v_pk_mul_f32 v[20:21], v[140:141], v[6:7] op_sel_hi:[1,0]
    v_pk_mul_f32 v[22:23], v[142:143], v[6:7] op_sel_hi:[1,0]
    v_max_f32 v128, 0, v128
    v_max_f32 v129, 0, v129
    v_max_f32 v130, 0, v130
    v_max_f32 v131, 0, v131
    v_max_f32 v132, 0, v132
    v_max_f32 v133, 0, v133
    v_max_f32 v134, 0, v134
    v_max_f32 v135, 0, v135
    v_max_f32 v136, 0, v136
    v_max_f32 v137, 0, v137
    v_max_f32 v138, 0, v138
    v_max_f32 v139, 0, v139
    v_max_f32 v140, 0, v140
    v_max_f32 v141, 0, v141
    v_max_f32 v142, 0, v142
    v_max_f32 v143, 0, v143
    v_exp_f32 v8, v8 clamp
    v_exp_f32 v9, v9 clamp
    v_exp_f32 v10, v10 clamp
    v_exp_f32 v11, v11 clamp
    v_exp_f32 v12, v12 clamp
    v_exp_f32 v13, v13 clamp
    v_exp_f32 v14, v14 clamp
    v_exp_f32 v15, v15 clamp
    v_exp_f32 v16, v16 clamp
    v_exp_f32 v17, v17 clamp
    v_exp_f32 v18, v18 clamp
    v_exp_f32 v19, v19 clamp
    v_exp_f32 v20, v20 clamp
    v_exp_f32 v21, v21 clamp
    v_exp_f32 v22, v22 clamp
    v_exp_f32 v23, v23 clamp
    v_pk_fma_f32 v[128:129], v[128:129], v[72:73], v[118:119] op_sel_hi:[1,0,0]
    v_pk_fma_f32 v[130:131], v[130:131], v[72:73], v[118:119] op_sel_hi:[1,0,0]
    v_pk_fma_f32 v[132:133], v[132:133], v[72:73], v[118:119] op_sel_hi:[1,0,0]
    v_pk_fma_f32 v[134:135], v[134:135], v[72:73], v[118:119] op_sel_hi:[1,0,0]
    v_pk_fma_f32 v[136:137], v[136:137], v[72:73], v[118:119] op_sel_hi:[1,0,0]
    v_pk_fma_f32 v[138:139], v[138:139], v[72:73], v[118:119] op_sel_hi:[1,0,0]
    v_pk_fma_f32 v[140:141], v[140:141], v[72:73], v[118:119] op_sel_hi:[1,0,0]
    v_pk_fma_f32 v[142:143], v[142:143], v[72:73], v[118:119] op_sel_hi:[1,0,0]
    v_pk_add_f32 v[8:9], v[8:9], v[128:129]
    v_pk_add_f32 v[10:11], v[10:11], v[130:131]
    v_pk_add_f32 v[12:13], v[12:13], v[132:133]
    v_pk_add_f32 v[14:15], v[14:15], v[134:135]
    v_pk_add_f32 v[16:17], v[16:17], v[136:137]
    v_pk_add_f32 v[18:19], v[18:19], v[138:139]
    v_pk_add_f32 v[20:21], v[20:21], v[140:141]
    v_pk_add_f32 v[22:23], v[22:23], v[142:143]
    v_cvt_pk_bf16_f32 v32, v8, v9
    v_cvt_pk_bf16_f32 v33, v10, v11
    v_cvt_pk_bf16_f32 v34, v12, v13
    v_cvt_pk_bf16_f32 v35, v14, v15
    v_cvt_pk_bf16_f32 v36, v16, v17
    v_cvt_pk_bf16_f32 v37, v18, v19
    v_cvt_pk_bf16_f32 v38, v20, v21
    v_cvt_pk_bf16_f32 v39, v22, v23
    v_pk_mul_f32 v[8:9], v[144:145], v[24:25] op_sel_hi:[1,0]
    v_pk_mul_f32 v[10:11], v[146:147], v[24:25] op_sel_hi:[1,0]
    v_pk_mul_f32 v[12:13], v[148:149], v[24:25] op_sel_hi:[1,0]
    v_pk_mul_f32 v[14:15], v[150:151], v[24:25] op_sel_hi:[1,0]
    v_pk_mul_f32 v[16:17], v[152:153], v[24:25] op_sel_hi:[1,0]
    v_pk_mul_f32 v[18:19], v[154:155], v[24:25] op_sel_hi:[1,0]
    v_pk_mul_f32 v[20:21], v[156:157], v[24:25] op_sel_hi:[1,0]
    v_pk_mul_f32 v[22:23], v[158:159], v[24:25] op_sel_hi:[1,0]
    v_max_f32 v144, 0, v144
    v_max_f32 v145, 0, v145
    v_max_f32 v146, 0, v146
    v_max_f32 v147, 0, v147
    v_max_f32 v148, 0, v148
    v_max_f32 v149, 0, v149
    v_max_f32 v150, 0, v150
    v_max_f32 v151, 0, v151
    v_max_f32 v152, 0, v152
    v_max_f32 v153, 0, v153
    v_max_f32 v154, 0, v154
    v_max_f32 v155, 0, v155
    v_max_f32 v156, 0, v156
    v_max_f32 v157, 0, v157
    v_max_f32 v158, 0, v158
    v_max_f32 v159, 0, v159
    v_exp_f32 v8, v8 clamp
    v_exp_f32 v9, v9 clamp
    v_exp_f32 v10, v10 clamp
    v_exp_f32 v11, v11 clamp
    v_exp_f32 v12, v12 clamp
    v_exp_f32 v13, v13 clamp
    v_exp_f32 v14, v14 clamp
    v_exp_f32 v15, v15 clamp
    v_exp_f32 v16, v16 clamp
    v_exp_f32 v17, v17 clamp
    v_exp_f32 v18, v18 clamp
    v_exp_f32 v19, v19 clamp
    v_exp_f32 v20, v20 clamp
    v_exp_f32 v21, v21 clamp
    v_exp_f32 v22, v22 clamp
    v_exp_f32 v23, v23 clamp
    v_pk_fma_f32 v[144:145], v[144:145], v[76:77], v[118:119] op_sel_hi:[1,0,0]
    v_pk_fma_f32 v[146:147], v[146:147], v[76:77], v[118:119] op_sel_hi:[1,0,0]
    v_pk_fma_f32 v[148:149], v[148:149], v[76:77], v[118:119] op_sel_hi:[1,0,0]
    v_pk_fma_f32 v[150:151], v[150:151], v[76:77], v[118:119] op_sel_hi:[1,0,0]
    v_pk_fma_f32 v[152:153], v[152:153], v[76:77], v[118:119] op_sel_hi:[1,0,0]
    v_pk_fma_f32 v[154:155], v[154:155], v[76:77], v[118:119] op_sel_hi:[1,0,0]
    v_pk_fma_f32 v[156:157], v[156:157], v[76:77], v[118:119] op_sel_hi:[1,0,0]
    v_pk_fma_f32 v[158:159], v[158:159], v[76:77], v[118:119] op_sel_hi:[1,0,0]
    v_pk_add_f32 v[8:9], v[8:9], v[144:145]
    v_pk_add_f32 v[10:11], v[10:11], v[146:147]
    v_pk_add_f32 v[12:13], v[12:13], v[148:149]
    v_pk_add_f32 v[14:15], v[14:15], v[150:151]
    v_pk_add_f32 v[16:17], v[16:17], v[152:153]
    v_pk_add_f32 v[18:19], v[18:19], v[154:155]
    v_pk_add_f32 v[20:21], v[20:21], v[156:157]
    v_pk_add_f32 v[22:23], v[22:23], v[158:159]
    v_cvt_pk_bf16_f32 v40, v8, v9
    v_cvt_pk_bf16_f32 v41, v10, v11
    v_cvt_pk_bf16_f32 v42, v12, v13
    v_cvt_pk_bf16_f32 v43, v14, v15
    v_cvt_pk_bf16_f32 v44, v16, v17
    v_cvt_pk_bf16_f32 v45, v18, v19
    v_cvt_pk_bf16_f32 v46, v20, v21
    v_cvt_pk_bf16_f32 v47, v22, v23
    v_mov_b32 v112, 0x3f803f80
    v_mov_b32 v113, 0x3f803f80
    v_mov_b32 v114, 0x3f803f80
    v_mov_b32 v115, 0x3f803f80
    s_waitcnt lgkmcnt(0)
    v_pk_mul_f32 v[160:161], v[160:161], v[48:49]
    v_pk_mul_f32 v[162:163], v[162:163], v[50:51]
    v_pk_mul_f32 v[164:165], v[164:165], v[52:53]
    v_pk_mul_f32 v[166:167], v[166:167], v[54:55]
    v_pk_mul_f32 v[168:169], v[168:169], v[56:57]
    v_pk_mul_f32 v[170:171], v[170:171], v[58:59]
    v_pk_mul_f32 v[172:173], v[172:173], v[60:61]
    v_pk_mul_f32 v[174:175], v[174:175], v[62:63]
    v_pk_mul_f32 v[192:193], v[192:193], v[48:49]
    v_pk_mul_f32 v[194:195], v[194:195], v[50:51]
    v_pk_mul_f32 v[196:197], v[196:197], v[52:53]
    v_pk_mul_f32 v[198:199], v[198:199], v[54:55]
    v_pk_mul_f32 v[200:201], v[200:201], v[56:57]
    v_pk_mul_f32 v[202:203], v[202:203], v[58:59]
    v_pk_mul_f32 v[204:205], v[204:205], v[60:61]
    v_pk_mul_f32 v[206:207], v[206:207], v[62:63]
    v_pk_mul_f32 v[8:9], v[160:161], v[116:117] op_sel_hi:[1,0]
    v_pk_mul_f32 v[10:11], v[162:163], v[116:117] op_sel_hi:[1,0]
    v_pk_mul_f32 v[12:13], v[164:165], v[116:117] op_sel_hi:[1,0]
    v_pk_mul_f32 v[14:15], v[166:167], v[116:117] op_sel_hi:[1,0]
    v_pk_mul_f32 v[16:17], v[168:169], v[116:117] op_sel_hi:[1,0]
    v_pk_mul_f32 v[18:19], v[170:171], v[116:117] op_sel_hi:[1,0]
    v_pk_mul_f32 v[20:21], v[172:173], v[116:117] op_sel_hi:[1,0]
    v_pk_mul_f32 v[22:23], v[174:175], v[116:117] op_sel_hi:[1,0]
    v_max_f32 v160, 0, v160
    v_max_f32 v161, 0, v161
    v_max_f32 v162, 0, v162
    v_max_f32 v163, 0, v163
    v_max_f32 v164, 0, v164
    v_max_f32 v165, 0, v165
    v_max_f32 v166, 0, v166
    v_max_f32 v167, 0, v167
    v_max_f32 v168, 0, v168
    v_max_f32 v169, 0, v169
    v_max_f32 v170, 0, v170
    v_max_f32 v171, 0, v171
    v_max_f32 v172, 0, v172
    v_max_f32 v173, 0, v173
    v_max_f32 v174, 0, v174
    v_max_f32 v175, 0, v175
    v_exp_f32 v8, v8 clamp
    v_exp_f32 v9, v9 clamp
    v_exp_f32 v10, v10 clamp
    v_exp_f32 v11, v11 clamp
    v_exp_f32 v12, v12 clamp
    v_exp_f32 v13, v13 clamp
    v_exp_f32 v14, v14 clamp
    v_exp_f32 v15, v15 clamp
    v_exp_f32 v16, v16 clamp
    v_exp_f32 v17, v17 clamp
    v_exp_f32 v18, v18 clamp
    v_exp_f32 v19, v19 clamp
    v_exp_f32 v20, v20 clamp
    v_exp_f32 v21, v21 clamp
    v_exp_f32 v22, v22 clamp
    v_exp_f32 v23, v23 clamp
    v_pk_add_f32 v[160:161], v[160:161], v[118:119] op_sel_hi:[1,0]
    v_pk_add_f32 v[162:163], v[162:163], v[118:119] op_sel_hi:[1,0]
    v_pk_add_f32 v[164:165], v[164:165], v[118:119] op_sel_hi:[1,0]
    v_pk_add_f32 v[166:167], v[166:167], v[118:119] op_sel_hi:[1,0]
    v_pk_add_f32 v[168:169], v[168:169], v[118:119] op_sel_hi:[1,0]
    v_pk_add_f32 v[170:171], v[170:171], v[118:119] op_sel_hi:[1,0]
    v_pk_add_f32 v[172:173], v[172:173], v[118:119] op_sel_hi:[1,0]
    v_pk_add_f32 v[174:175], v[174:175], v[118:119] op_sel_hi:[1,0]
    v_cvt_pk_bf16_f32 v104, v192, v193
    v_cvt_pk_bf16_f32 v105, v194, v195
    v_cvt_pk_bf16_f32 v106, v196, v197
    v_cvt_pk_bf16_f32 v107, v198, v199
    v_cvt_pk_bf16_f32 v108, v200, v201
    v_cvt_pk_bf16_f32 v109, v202, v203
    v_cvt_pk_bf16_f32 v110, v204, v205
    v_cvt_pk_bf16_f32 v111, v206, v207
    v_pk_add_f32 v[8:9], v[8:9], v[160:161]
    v_pk_add_f32 v[10:11], v[10:11], v[162:163]
    v_pk_add_f32 v[12:13], v[12:13], v[164:165]
    v_pk_add_f32 v[14:15], v[14:15], v[166:167]
    v_pk_add_f32 v[16:17], v[16:17], v[168:169]
    v_pk_add_f32 v[18:19], v[18:19], v[170:171]
    v_pk_add_f32 v[20:21], v[20:21], v[172:173]
    v_pk_add_f32 v[22:23], v[22:23], v[174:175]
    v_cvt_pk_bf16_f32 v96, v8, v9
    v_cvt_pk_bf16_f32 v97, v10, v11
    v_cvt_pk_bf16_f32 v98, v12, v13
    v_cvt_pk_bf16_f32 v99, v14, v15
    v_cvt_pk_bf16_f32 v100, v16, v17
    v_cvt_pk_bf16_f32 v101, v18, v19
    v_cvt_pk_bf16_f32 v102, v20, v21
    v_cvt_pk_bf16_f32 v103, v22, v23
    s_nop 1
    v_mfma_f32_32x32x16_bf16 v[128:143], v[96:99], v[104:107], 0
    v_mfma_f32_32x32x16_bf16 v[144:159], v[96:99], v[112:115], 0
    v_mfma_f32_32x32x16_bf16 v[128:143], v[100:103], v[108:111], v[128:143]
    v_mfma_f32_32x32x16_bf16 v[144:159], v[100:103], v[112:115], v[144:159]
    ds_read_b128 v[48:51], v5 offset:128
    ds_read_b128 v[52:55], v5 offset:160
    ds_read_b128 v[56:59], v5 offset:192
    ds_read_b128 v[60:63], v5 offset:224
    s_waitcnt lgkmcnt(0)
    v_pk_mul_f32 v[176:177], v[176:177], v[48:49]
    v_pk_mul_f32 v[178:179], v[178:179], v[50:51]
    v_pk_mul_f32 v[180:181], v[180:181], v[52:53]
    v_pk_mul_f32 v[182:183], v[182:183], v[54:55]
    v_pk_mul_f32 v[184:185], v[184:185], v[56:57]
    v_pk_mul_f32 v[186:187], v[186:187], v[58:59]
    v_pk_mul_f32 v[188:189], v[188:189], v[60:61]
    v_pk_mul_f32 v[190:191], v[190:191], v[62:63]
    v_pk_mul_f32 v[208:209], v[208:209], v[48:49]
    v_pk_mul_f32 v[210:211], v[210:211], v[50:51]
    v_pk_mul_f32 v[212:213], v[212:213], v[52:53]
    v_pk_mul_f32 v[214:215], v[214:215], v[54:55]
    v_pk_mul_f32 v[216:217], v[216:217], v[56:57]
    v_pk_mul_f32 v[218:219], v[218:219], v[58:59]
    v_pk_mul_f32 v[220:221], v[220:221], v[60:61]
    v_pk_mul_f32 v[222:223], v[222:223], v[62:63]
    v_pk_mul_f32 v[8:9], v[176:177], v[116:117] op_sel_hi:[1,0]
    v_pk_mul_f32 v[10:11], v[178:179], v[116:117] op_sel_hi:[1,0]
    v_pk_mul_f32 v[12:13], v[180:181], v[116:117] op_sel_hi:[1,0]
    v_pk_mul_f32 v[14:15], v[182:183], v[116:117] op_sel_hi:[1,0]
    v_pk_mul_f32 v[16:17], v[184:185], v[116:117] op_sel_hi:[1,0]
    v_pk_mul_f32 v[18:19], v[186:187], v[116:117] op_sel_hi:[1,0]
    v_pk_mul_f32 v[20:21], v[188:189], v[116:117] op_sel_hi:[1,0]
    v_pk_mul_f32 v[22:23], v[190:191], v[116:117] op_sel_hi:[1,0]
    v_max_f32 v176, 0, v176
    v_max_f32 v177, 0, v177
    v_max_f32 v178, 0, v178
    v_max_f32 v179, 0, v179
    v_max_f32 v180, 0, v180
    v_max_f32 v181, 0, v181
    v_max_f32 v182, 0, v182
    v_max_f32 v183, 0, v183
    v_max_f32 v184, 0, v184
    v_max_f32 v185, 0, v185
    v_max_f32 v186, 0, v186
    v_max_f32 v187, 0, v187
    v_max_f32 v188, 0, v188
    v_max_f32 v189, 0, v189
    v_max_f32 v190, 0, v190
    v_max_f32 v191, 0, v191
    v_exp_f32 v8, v8 clamp
    v_exp_f32 v9, v9 clamp
    v_exp_f32 v10, v10 clamp
    v_exp_f32 v11, v11 clamp
    v_exp_f32 v12, v12 clamp
    v_exp_f32 v13, v13 clamp
    v_exp_f32 v14, v14 clamp
    v_exp_f32 v15, v15 clamp
    v_exp_f32 v16, v16 clamp
    v_exp_f32 v17, v17 clamp
    v_exp_f32 v18, v18 clamp
    v_exp_f32 v19, v19 clamp
    v_exp_f32 v20, v20 clamp
    v_exp_f32 v21, v21 clamp
    v_exp_f32 v22, v22 clamp
    v_exp_f32 v23, v23 clamp
    v_pk_add_f32 v[176:177], v[176:177], v[118:119] op_sel_hi:[1,0]
    v_pk_add_f32 v[178:179], v[178:179], v[118:119] op_sel_hi:[1,0]
    v_pk_add_f32 v[180:181], v[180:181], v[118:119] op_sel_hi:[1,0]
    v_pk_add_f32 v[182:183], v[182:183], v[118:119] op_sel_hi:[1,0]
    v_pk_add_f32 v[184:185], v[184:185], v[118:119] op_sel_hi:[1,0]
    v_pk_add_f32 v[186:187], v[186:187], v[118:119] op_sel_hi:[1,0]
    v_pk_add_f32 v[188:189], v[188:189], v[118:119] op_sel_hi:[1,0]
    v_pk_add_f32 v[190:191], v[190:191], v[118:119] op_sel_hi:[1,0]
    v_cvt_pk_bf16_f32 v104, v208, v209
    v_cvt_pk_bf16_f32 v105, v210, v211
    v_cvt_pk_bf16_f32 v106, v212, v213
    v_cvt_pk_bf16_f32 v107, v214, v215
    v_cvt_pk_bf16_f32 v108, v216, v217
    v_cvt_pk_bf16_f32 v109, v218, v219
    v_cvt_pk_bf16_f32 v110, v220, v221
    v_cvt_pk_bf16_f32 v111, v222, v223
    v_pk_add_f32 v[8:9], v[8:9], v[176:177]
    v_pk_add_f32 v[10:11], v[10:11], v[178:179]
    v_pk_add_f32 v[12:13], v[12:13], v[180:181]
    v_pk_add_f32 v[14:15], v[14:15], v[182:183]
    v_pk_add_f32 v[16:17], v[16:17], v[184:185]
    v_pk_add_f32 v[18:19], v[18:19], v[186:187]
    v_pk_add_f32 v[20:21], v[20:21], v[188:189]
    v_pk_add_f32 v[22:23], v[22:23], v[190:191]
    v_cvt_pk_bf16_f32 v96, v8, v9
    v_cvt_pk_bf16_f32 v97, v10, v11
    v_cvt_pk_bf16_f32 v98, v12, v13
    v_cvt_pk_bf16_f32 v99, v14, v15
    v_cvt_pk_bf16_f32 v100, v16, v17
    v_cvt_pk_bf16_f32 v101, v18, v19
    v_cvt_pk_bf16_f32 v102, v20, v21
    v_cvt_pk_bf16_f32 v103, v22, v23
    s_nop 1
    v_mfma_f32_32x32x16_bf16 v[128:143], v[96:99], v[104:107], v[128:143]
    v_mfma_f32_32x32x16_bf16 v[144:159], v[96:99], v[112:115], v[144:159]
    v_mfma_f32_32x32x16_bf16 v[128:143], v[100:103], v[108:111], v[128:143]
    v_mfma_f32_32x32x16_bf16 v[144:159], v[100:103], v[112:115], v[144:159]
    buffer_store_dwordx4 v[32:35], v4, s[16:19], s48 offen offset:0 sc1
    buffer_store_dwordx4 v[36:39], v4, s[16:19], s48 offen offset:1024 sc1
    buffer_store_dwordx4 v[40:43], v4, s[16:19], s51 offen offset:0 sc1
    buffer_store_dwordx4 v[44:47], v4, s[16:19], s51 offen offset:1024 sc1
    v_and_b32 v8, 15, v2
    v_lshrrev_b32 v9, 5, v2
    v_lshl_add_u32 v8, v9, 4, v8
    v_lshlrev_b32 v8, 4, v8
    v_bfe_u32 v10, v2, 4, 1
    v_lshl_add_u32 v8, v10, 10, v8
    s_mul_i32 s48, s46, 4352
    s_add_u32 s48, s48, 132096
    s_lshl_b32 s49, s47, 11
    s_add_u32 s49, s48, s49
    v_add_u32 v8, s49, v8
    s_lshl_b32 s49, s47, 7
    s_add_u32 s49, s48, s49
    v_lshl_add_u32 v9, v9, 4, s49
    s_nop 7
    s_mov_b32 exec_lo, 0x0000ffff
    s_mov_b32 exec_hi, 0x0000ffff
    ds_write_b128 v8, v[128:131]
    ds_write_b128 v8, v[132:135] offset:512
    s_mov_b32 exec_lo, 0xffff0000
    s_mov_b32 exec_hi, 0xffff0000
    ds_write_b128 v8, v[136:139]
    ds_write_b128 v8, v[140:143] offset:512
    s_mov_b32 exec_lo, 1
    s_mov_b32 exec_hi, 1
    ds_write_b128 v9, v[144:147] offset:4096
    ds_write_b128 v9, v[148:151] offset:4128
    ds_write_b128 v9, v[152:155] offset:4160
    ds_write_b128 v9, v[156:159] offset:4192
    s_mov_b64 exec, -1
    s_mul_i32 s48, s46, 4352
    s_add_u32 s48, s48, 132096
    s_lshl_b32 s49, s47, 11
    s_add_u32 s49, s48, s49
    v_lshlrev_b32 v3, 2, v2
    v_add_u32 v4, s49, v3
    s_lshl_b32 s49, s47, 7
    s_add_u32 s49, s48, s49
    s_add_u32 s49, s49, 4096
    v_add_u32 v5, s49, v3
    s_waitcnt lgkmcnt(0)
    ds_read_b32 v8, v4 offset:0
    ds_read_b32 v9, v4 offset:256
    ds_read_b32 v10, v4 offset:512
    ds_read_b32 v11, v4 offset:768
    ds_read_b32 v12, v4 offset:1024
    ds_read_b32 v13, v4 offset:1280
    ds_read_b32 v14, v4 offset:1536
    ds_read_b32 v15, v4 offset:1792
    ds_read_b32 v16, v5
    s_lshl_b32 s48, s5, 12
    s_lshl_b32 s49, s47, 11
    s_add_u32 s48, s48, s49
    s_add_u32 s48, s48, 7733248
    s_lshl_b32 s50, s5, 8
    s_lshl_b32 s49, s47, 7
    s_add_u32 s50, s50, s49
    s_add_u32 s50, s50, 7766016
    s_waitcnt lgkmcnt(8)
    buffer_atomic_add_f32 v8, v3, s[16:19], s48 offen offset:0
    s_waitcnt lgkmcnt(7)
    buffer_atomic_add_f32 v9, v3, s[16:19], s48 offen offset:256
    s_waitcnt lgkmcnt(6)
    buffer_atomic_add_f32 v10, v3, s[16:19], s48 offen offset:512
    s_waitcnt lgkmcnt(5)
    buffer_atomic_add_f32 v11, v3, s[16:19], s48 offen offset:768
    s_waitcnt lgkmcnt(4)
    buffer_atomic_add_f32 v12, v3, s[16:19], s48 offen offset:1024
    s_waitcnt lgkmcnt(3)
    buffer_atomic_add_f32 v13, v3, s[16:19], s48 offen offset:1280
    s_waitcnt lgkmcnt(2)
    buffer_atomic_add_f32 v14, v3, s[16:19], s48 offen offset:1536
    s_waitcnt lgkmcnt(1)
    buffer_atomic_add_f32 v15, v3, s[16:19], s48 offen offset:1792
    s_waitcnt lgkmcnt(0)
    s_mov_b32 exec_hi, 0
    buffer_atomic_add_f32 v16, v3, s[16:19], s50 offen
    s_mov_b32 exec_hi, -1
K1_END:
    s_xor_b32 s53, s7, 1
    s_lshl_b32 s53, s53, 4
    s_add_u32 s53, s53, s4
    s_lshl_b32 s53, s53, 3
    s_and_b32 s54, s5, 7
    s_add_u32 s53, s53, s54
    s_lshl_b32 s53, s53, 2
    s_add_u32 s53, s53, s3
    s_lshl_b32 s53, s53, 2
    s_add_u32 s53, s53, 8068096
    v_mov_b32 v24, s59
    v_mov_b32 v25, 0
    s_waitcnt vmcnt(0)
    s_mov_b64 exec, 1
    buffer_store_dword v24, v25, s[16:19], s53 offen sc1
    s_mov_b64 exec, -1
    s_branch K2_CENTRY
K1_EXIT0:
    s_endpgm
K1_CF:
K1_MLF:
    s_barrier
    v_mfma_f32_32x32x16_bf16 v[128:143], v[92:95], v[84:87], v[128:143]
    ds_read_b128 v[64:67], v104
    ds_read_b64_tr_b16 v[72:73], v108 offset:0
    ds_read_b64_tr_b16 v[74:75], v108 offset:512
    v_mfma_f32_32x32x16_bf16 v[144:159], v[92:95], v[88:91], v[144:159]
    ds_read_b128 v[68:71], v104 offset:4096
    ds_read_b64_tr_b16 v[76:77], v110 offset:0
    ds_read_b64_tr_b16 v[78:79], v110 offset:512
    v_mfma_f32_32x32x16_bf16 v[160:175], v[96:99], v[84:87], v[160:175]
    ds_read_b64_tr_b16 v[80:81], v112 offset:0
    ds_read_b64_tr_b16 v[82:83], v112 offset:512
    v_mfma_f32_32x32x16_bf16 v[176:191], v[96:99], v[88:91], v[176:191]
    v_mfma_f32_32x32x16_bf16 v[192:207], v[100:103], v[84:87], v[192:207]
    v_mfma_f32_32x32x16_bf16 v[208:223], v[100:103], v[88:91], v[208:223]
    s_waitcnt lgkmcnt(5)
    v_mfma_f32_32x32x16_bf16 v[128:143], v[72:75], v[64:67], v[128:143]
    ds_read_b128 v[84:87], v105
    ds_read_b64_tr_b16 v[92:93], v109 offset:2048
    ds_read_b64_tr_b16 v[94:95], v109 offset:2560
    s_waitcnt lgkmcnt(7)
    v_mfma_f32_32x32x16_bf16 v[144:159], v[72:75], v[68:71], v[144:159]
    ds_read_b128 v[88:91], v105 offset:4096
    ds_read_b64_tr_b16 v[96:97], v111 offset:2048
    ds_read_b64_tr_b16 v[98:99], v111 offset:2560
    s_waitcnt lgkmcnt(8)
    v_mfma_f32_32x32x16_bf16 v[160:175], v[76:79], v[64:67], v[160:175]
    ds_read_b64_tr_b16 v[100:101], v113 offset:2048
    ds_read_b64_tr_b16 v[102:103], v113 offset:2560
    v_mfma_f32_32x32x16_bf16 v[176:191], v[76:79], v[68:71], v[176:191]
    s_waitcnt lgkmcnt(8)
    v_mfma_f32_32x32x16_bf16 v[192:207], v[80:83], v[64:67], v[192:207]
    v_mfma_f32_32x32x16_bf16 v[208:223], v[80:83], v[68:71], v[208:223]
    s_waitcnt lgkmcnt(5)
    v_mfma_f32_32x32x16_bf16 v[128:143], v[92:95], v[84:87], v[128:143]
    ds_read_b128 v[64:67], v106
    ds_read_b64_tr_b16 v[72:73], v108 offset:4096
    ds_read_b64_tr_b16 v[74:75], v108 offset:4608
    s_waitcnt lgkmcnt(7)
    v_mfma_f32_32x32x16_bf16 v[144:159], v[92:95], v[88:91], v[144:159]
    ds_read_b128 v[68:71], v106 offset:4096
    ds_read_b64_tr_b16 v[76:77], v110 offset:4096
    ds_read_b64_tr_b16 v[78:79], v110 offset:4608
    s_waitcnt lgkmcnt(8)
    v_mfma_f32_32x32x16_bf16 v[160:175], v[96:99], v[84:87], v[160:175]
    ds_read_b64_tr_b16 v[80:81], v112 offset:4096
    ds_read_b64_tr_b16 v[82:83], v112 offset:4608
    v_mfma_f32_32x32x16_bf16 v[176:191], v[96:99], v[88:91], v[176:191]
    s_waitcnt lgkmcnt(8)
    v_mfma_f32_32x32x16_bf16 v[192:207], v[100:103], v[84:87], v[192:207]
    v_mfma_f32_32x32x16_bf16 v[208:223], v[100:103], v[88:91], v[208:223]
    s_waitcnt lgkmcnt(5)
    v_mfma_f32_32x32x16_bf16 v[128:143], v[72:75], v[64:67], v[128:143]
    ds_read_b128 v[84:87], v107
    ds_read_b64_tr_b16 v[92:93], v109 offset:6144
    ds_read_b64_tr_b16 v[94:95], v109 offset:6656
    s_waitcnt lgkmcnt(7)
    v_mfma_f32_32x32x16_bf16 v[144:159], v[72:75], v[68:71], v[144:159]
    ds_read_b128 v[88:91], v107 offset:4096
    ds_read_b64_tr_b16 v[96:97], v111 offset:6144
    ds_read_b64_tr_b16 v[98:99], v111 offset:6656
    s_waitcnt lgkmcnt(8)
    v_mfma_f32_32x32x16_bf16 v[160:175], v[76:79], v[64:67], v[160:175]
    ds_read_b64_tr_b16 v[100:101], v113 offset:6144
    ds_read_b64_tr_b16 v[102:103], v113 offset:6656
    v_mfma_f32_32x32x16_bf16 v[176:191], v[76:79], v[68:71], v[176:191]
    s_add_u32 s49, s49, s64
    s_cmp_eq_u32 s49, 122880
    s_cselect_b32 s50, s65, s64
    s_cselect_b32 s49, 0, s49
    s_waitcnt lgkmcnt(8)
    v_mfma_f32_32x32x16_bf16 v[192:207], v[80:83], v[64:67], v[192:207]
    v_add_u32 v104, s50, v104
    v_add_u32 v105, s50, v105
    v_add_u32 v106, s50, v106
    v_add_u32 v107, s50, v107
    v_add_u32 v108, s50, v108
    v_mfma_f32_32x32x16_bf16 v[208:223], v[80:83], v[68:71], v[208:223]
    v_add_u32 v109, s50, v109
    v_add_u32 v110, s50, v110
    v_add_u32 v111, s50, v111
    v_add_u32 v112, s50, v112
    v_add_u32 v113, s50, v113
    s_waitcnt lgkmcnt(0)
    s_cmp_lg_u32 s48, 8
    s_cbranch_scc1 K1_NSTF
    v_mov_b32 v12, 0x3f803f80
    v_mov_b32 v24, 0
    v_mov_b32 v26, 0
    v_mov_b32 v28, 0
    v_mov_b32 v30, 0
    s_waitcnt vmcnt(0)
    v_dot2_f32_bf16 v24, v16, v12, v24
    v_dot2_f32_bf16 v26, v16, v16, v26
    v_dot2_f32_bf16 v28, v20, v12, v28
    v_dot2_f32_bf16 v30, v20, v20, v30
    v_dot2_f32_bf16 v24, v17, v12, v24
    v_dot2_f32_bf16 v26, v17, v17, v26
    v_dot2_f32_bf16 v28, v21, v12, v28
    v_dot2_f32_bf16 v30, v21, v21, v30
    v_dot2_f32_bf16 v24, v18, v12, v24
    v_dot2_f32_bf16 v26, v18, v18, v26
    v_dot2_f32_bf16 v28, v22, v12, v28
    v_dot2_f32_bf16 v30, v22, v22, v30
    v_dot2_f32_bf16 v24, v19, v12, v24
    v_dot2_f32_bf16 v26, v19, v19, v26
    v_dot2_f32_bf16 v28, v23, v12, v28
    v_dot2_f32_bf16 v30, v23, v23, v30
    s_nop 2
    v_add_f32_dpp v24, v24, v24 row_shr:1 row_mask:0xf bank_mask:0xf bound_ctrl:0
    v_add_f32_dpp v26, v26, v26 row_shr:1 row_mask:0xf bank_mask:0xf bound_ctrl:0
    v_add_f32_dpp v28, v28, v28 row_shr:1 row_mask:0xf bank_mask:0xf bound_ctrl:0
    v_add_f32_dpp v30, v30, v30 row_shr:1 row_mask:0xf bank_mask:0xf bound_ctrl:0
    v_add_f32_dpp v24, v24, v24 row_shr:2 row_mask:0xf bank_mask:0xf bound_ctrl:0
    v_add_f32_dpp v26, v26, v26 row_shr:2 row_mask:0xf bank_mask:0xf bound_ctrl:0
    v_add_f32_dpp v28, v28, v28 row_shr:2 row_mask:0xf bank_mask:0xf bound_ctrl:0
    v_add_f32_dpp v30, v30, v30 row_shr:2 row_mask:0xf bank_mask:0xf bound_ctrl:0
    v_add_f32_dpp v24, v24, v24 row_shr:4 row_mask:0xf bank_mask:0xf bound_ctrl:0
    v_add_f32_dpp v26, v26, v26 row_shr:4 row_mask:0xf bank_mask:0xf bound_ctrl:0
    v_add_f32_dpp v28, v28, v28 row_shr:4 row_mask:0xf bank_mask:0xf bound_ctrl:0
    v_add_f32_dpp v30, v30, v30 row_shr:4 row_mask:0xf bank_mask:0xf bound_ctrl:0
    v_add_f32_dpp v24, v24, v24 row_shr:8 row_mask:0xf bank_mask:0xf bound_ctrl:0
    v_add_f32_dpp v26, v26, v26 row_shr:8 row_mask:0xf bank_mask:0xf bound_ctrl:0
    v_add_f32_dpp v28, v28, v28 row_shr:8 row_mask:0xf bank_mask:0xf bound_ctrl:0
    v_add_f32_dpp v30, v30, v30 row_shr:8 row_mask:0xf bank_mask:0xf bound_ctrl:0
    v_add_f32_dpp v24, v24, v24 row_bcast:15 row_mask:0xa bank_mask:0xf
    v_add_f32_dpp v26, v26, v26 row_bcast:15 row_mask:0xa bank_mask:0xf
    v_add_f32_dpp v28, v28, v28 row_bcast:15 row_mask:0xa bank_mask:0xf
    v_add_f32_dpp v30, v30, v30 row_bcast:15 row_mask:0xa bank_mask:0xf
    v_add_f32_dpp v24, v24, v24 row_bcast:31 row_mask:0xc bank_mask:0xf
    v_add_f32_dpp v26, v26, v26 row_bcast:31 row_mask:0xc bank_mask:0xf
    v_add_f32_dpp v28, v28, v28 row_bcast:31 row_mask:0xc bank_mask:0xf
    v_add_f32_dpp v30, v30, v30 row_bcast:31 row_mask:0xc bank_mask:0xf
    v_mul_f32 v32, 0xbb000000, v24
    v_mul_f32 v33, 0x3b000000, v26
    v_fma_f32 v33, -v32, v32, v33
    v_max_f32 v33, 0, v33
    v_add_f32 v33, 0x3727c5ac, v33
    v_mul_f32 v36, 0xbb000000, v28
    v_mul_f32 v37, 0x3b000000, v30
    v_fma_f32 v37, -v36, v36, v37
    v_max_f32 v37, 0, v37
    v_add_f32 v37, 0x3727c5ac, v37
K1_NSTF:
    s_cmp_lg_u32 s48, 7
    s_cbranch_scc1 K1_NPUBF
    v_mov_b32 v4, 122880
    ds_read_b32 v34, v4
    v_mov_b32 v4, 0
    s_waitcnt lgkmcnt(0)
    v_readfirstlane_b32 s59, v34
    v_mov_b32 v35, v34
    v_mov_b32 v38, v34
    v_mov_b32 v39, v34
    s_mov_b32 exec_lo, 0
    s_mov_b32 exec_hi, 0x80000000
    buffer_store_dwordx4 v[32:35], v4, s[16:19], s56 offen sc1
    buffer_store_dwordx4 v[36:39], v4, s[16:19], s56 offen offset:16 sc1
    s_mov_b64 exec, -1
K1_NPUBF:
    s_sub_u32 s48, s48, 1
    s_cmp_lg_u32 s48, 0
    s_cbranch_scc1 K1_MLF
    v_mfma_f32_32x32x16_bf16 v[128:143], v[92:95], v[84:87], v[128:143]
    v_mfma_f32_32x32x16_bf16 v[144:159], v[92:95], v[88:91], v[144:159]
    v_mfma_f32_32x32x16_bf16 v[160:175], v[96:99], v[84:87], v[160:175]
    v_mfma_f32_32x32x16_bf16 v[176:191], v[96:99], v[88:91], v[176:191]
    v_mfma_f32_32x32x16_bf16 v[192:207], v[100:103], v[84:87], v[192:207]
    v_mfma_f32_32x32x16_bf16 v[208:223], v[100:103], v[88:91], v[208:223]
    v_and_b32 v3, 31, v2
    s_lshl_b32 s48, s46, 6
    v_add_u32 v4, s48, v3
    v_lshlrev_b32 v4, 5, v4
    v_add_u32 v4, 123904, v4
    v_mov_b32 v5, 122896
    v_cmp_gt_u32 vcc, 32, v2
    s_mul_i32 s49, s47, 1536
    s_add_u32 s49, s49, 128512
    v_lshl_add_u32 v6, v3, 4, s49
    v_cndmask_b32 v5, v5, v4, vcc
    v_add_u32 v7, 1024, v4
    v_mov_b32 v8, 122896
    v_cndmask_b32 v7, v8, v7, vcc
    s_barrier
    ds_read_b128 v[80:83], v6
    ds_read_b128 v[64:67], v5
    ds_read_b128 v[68:71], v7
    ds_read_b128 v[84:87], v6 offset:512
    ds_read_b128 v[88:91], v6 offset:1024
    ds_read_b128 v[72:75], v4 offset:16
    ds_read_b128 v[76:79], v4 offset:1040
    s_waitcnt lgkmcnt(5)
    v_mfma_f32_32x32x16_bf16 v[128:143], v[80:83], v[64:67], v[128:143]
    s_waitcnt lgkmcnt(4)
    v_mfma_f32_32x32x16_bf16 v[144:159], v[80:83], v[68:71], v[144:159]
    s_waitcnt lgkmcnt(3)
    v_mfma_f32_32x32x16_bf16 v[160:175], v[84:87], v[64:67], v[160:175]
    v_mfma_f32_32x32x16_bf16 v[176:191], v[84:87], v[68:71], v[176:191]
    s_waitcnt lgkmcnt(2)
    v_mfma_f32_32x32x16_bf16 v[192:207], v[88:91], v[64:67], v[192:207]
    v_mfma_f32_32x32x16_bf16 v[208:223], v[88:91], v[68:71], v[208:223]
    s_waitcnt lgkmcnt(0)
    v_lshlrev_b32 v4, 4, v2
    s_lshl_b32 s48, s4, 2
    s_lshl_b32 s49, s46, 1
    s_add_u32 s48, s48, s49
    s_mul_i32 s48, s48, 86
    s_mul_i32 s49, s47, 3
    s_add_u32 s49, s49, s44
    s_lshl_b32 s50, s49, 1
    s_add_u32 s48, s48, s50
    s_lshl_b32 s48, s48, 10
    s_add_u32 s51, s48, 88064
    s_mul_i32 s52, s47, 3
    s_sub_u32 s52, s45, s52
    v_pk_mul_f32 v[8:9], v[128:129], v[128:129]
    v_pk_mul_f32 v[10:11], v[130:131], v[130:131]
    v_pk_mul_f32 v[12:13], v[132:133], v[132:133]
    v_pk_mul_f32 v[14:15], v[134:135], v[134:135]
    v_pk_mul_f32 v[16:17], v[136:137], v[136:137]
    v_pk_mul_f32 v[18:19], v[138:139], v[138:139]
    v_pk_mul_f32 v[20:21], v[140:141], v[140:141]
    v_pk_mul_f32 v[22:23], v[142:143], v[142:143]
    v_pk_fma_f32 v[8:9], v[8:9], v[74:75], v[74:75] op_sel:[0,0,1] op_sel_hi:[1,0,1]
    v_pk_fma_f32 v[10:11], v[10:11], v[74:75], v[74:75] op_sel:[0,0,1] op_sel_hi:[1,0,1]
    v_pk_fma_f32 v[12:13], v[12:13], v[74:75], v[74:75] op_sel:[0,0,1] op_sel_hi:[1,0,1]
    v_pk_fma_f32 v[14:15], v[14:15], v[74:75], v[74:75] op_sel:[0,0,1] op_sel_hi:[1,0,1]
    v_pk_fma_f32 v[16:17], v[16:17], v[74:75], v[74:75] op_sel:[0,0,1] op_sel_hi:[1,0,1]
    v_pk_fma_f32 v[18:19], v[18:19], v[74:75], v[74:75] op_sel:[0,0,1] op_sel_hi:[1,0,1]
    v_pk_fma_f32 v[20:21], v[20:21], v[74:75], v[74:75] op_sel:[0,0,1] op_sel_hi:[1,0,1]
    v_pk_fma_f32 v[22:23], v[22:23], v[74:75], v[74:75] op_sel:[0,0,1] op_sel_hi:[1,0,1]
    v_pk_mul_f32 v[8:9], v[8:9], v[128:129]
    v_pk_mul_f32 v[10:11], v[10:11], v[130:131]
    v_pk_mul_f32 v[12:13], v[12:13], v[132:133]
    v_pk_mul_f32 v[14:15], v[14:15], v[134:135]
    v_pk_mul_f32 v[16:17], v[16:17], v[136:137]
    v_pk_mul_f32 v[18:19], v[18:19], v[138:139]
    v_pk_mul_f32 v[20:21], v[20:21], v[140:141]
    v_pk_mul_f32 v[22:23], v[22:23], v[142:143]
    v_exp_f32 v8, v8
    v_exp_f32 v9, v9
    v_exp_f32 v10, v10
    v_exp_f32 v11, v11
    v_exp_f32 v12, v12
    v_exp_f32 v13, v13
    v_exp_f32 v14, v14
    v_exp_f32 v15, v15
    v_exp_f32 v16, v16
    v_exp_f32 v17, v17
    v_exp_f32 v18, v18
    v_exp_f32 v19, v19
    v_exp_f32 v20, v20
    v_exp_f32 v21, v21
    v_exp_f32 v22, v22
    v_exp_f32 v23, v23
    v_pk_fma_f32 v[8:9], v[8:9], v[72:73], v[72:73] op_sel:[0,1,1] op_sel_hi:[1,1,1]
    v_pk_fma_f32 v[10:11], v[10:11], v[72:73], v[72:73] op_sel:[0,1,1] op_sel_hi:[1,1,1]
    v_pk_fma_f32 v[12:13], v[12:13], v[72:73], v[72:73] op_sel:[0,1,1] op_sel_hi:[1,1,1]
    v_pk_fma_f32 v[14:15], v[14:15], v[72:73], v[72:73] op_sel:[0,1,1] op_sel_hi:[1,1,1]
    v_pk_fma_f32 v[16:17], v[16:17], v[72:73], v[72:73] op_sel:[0,1,1] op_sel_hi:[1,1,1]
    v_pk_fma_f32 v[18:19], v[18:19], v[72:73], v[72:73] op_sel:[0,1,1] op_sel_hi:[1,1,1]
    v_pk_fma_f32 v[20:21], v[20:21], v[72:73], v[72:73] op_sel:[0,1,1] op_sel_hi:[1,1,1]
    v_pk_fma_f32 v[22:23], v[22:23], v[72:73], v[72:73] op_sel:[0,1,1] op_sel_hi:[1,1,1]
    v_rcp_f32 v8, v8
    v_rcp_f32 v9, v9
    v_rcp_f32 v10, v10
    v_rcp_f32 v11, v11
    v_rcp_f32 v12, v12
    v_rcp_f32 v13, v13
    v_rcp_f32 v14, v14
    v_rcp_f32 v15, v15
    v_rcp_f32 v16, v16
    v_rcp_f32 v17, v17
    v_rcp_f32 v18, v18
    v_rcp_f32 v19, v19
    v_rcp_f32 v20, v20
    v_rcp_f32 v21, v21
    v_rcp_f32 v22, v22
    v_rcp_f32 v23, v23
    v_pk_mul_f32 v[8:9], v[8:9], v[128:129]
    v_pk_mul_f32 v[10:11], v[10:11], v[130:131]
    v_pk_mul_f32 v[12:13], v[12:13], v[132:133]
    v_pk_mul_f32 v[14:15], v[14:15], v[134:135]
    v_pk_mul_f32 v[16:17], v[16:17], v[136:137]
    v_pk_mul_f32 v[18:19], v[18:19], v[138:139]
    v_pk_mul_f32 v[20:21], v[20:21], v[140:141]
    v_pk_mul_f32 v[22:23], v[22:23], v[142:143]
    v_cvt_pk_bf16_f32 v48, v8, v9
    v_cvt_pk_bf16_f32 v49, v10, v11
    v_cvt_pk_bf16_f32 v50, v12, v13
    v_cvt_pk_bf16_f32 v51, v14, v15
    v_cvt_pk_bf16_f32 v52, v16, v17
    v_cvt_pk_bf16_f32 v53, v18, v19
    v_cvt_pk_bf16_f32 v54, v20, v21
    v_cvt_pk_bf16_f32 v55, v22, v23
    buffer_store_dwordx4 v[48:51], v4, s[16:19], s48 offen offset:0 sc1
    buffer_store_dwordx4 v[52:55], v4, s[16:19], s48 offen offset:1024 sc1
    v_pk_mul_f32 v[8:9], v[144:145], v[144:145]
    v_pk_mul_f32 v[10:11], v[146:147], v[146:147]
    v_pk_mul_f32 v[12:13], v[148:149], v[148:149]
    v_pk_mul_f32 v[14:15], v[150:151], v[150:151]
    v_pk_mul_f32 v[16:17], v[152:153], v[152:153]
    v_pk_mul_f32 v[18:19], v[154:155], v[154:155]
    v_pk_mul_f32 v[20:21], v[156:157], v[156:157]
    v_pk_mul_f32 v[22:23], v[158:159], v[158:159]
    v_pk_fma_f32 v[8:9], v[8:9], v[78:79], v[78:79] op_sel:[0,0,1] op_sel_hi:[1,0,1]
    v_pk_fma_f32 v[10:11], v[10:11], v[78:79], v[78:79] op_sel:[0,0,1] op_sel_hi:[1,0,1]
    v_pk_fma_f32 v[12:13], v[12:13], v[78:79], v[78:79] op_sel:[0,0,1] op_sel_hi:[1,0,1]
    v_pk_fma_f32 v[14:15], v[14:15], v[78:79], v[78:79] op_sel:[0,0,1] op_sel_hi:[1,0,1]
    v_pk_fma_f32 v[16:17], v[16:17], v[78:79], v[78:79] op_sel:[0,0,1] op_sel_hi:[1,0,1]
    v_pk_fma_f32 v[18:19], v[18:19], v[78:79], v[78:79] op_sel:[0,0,1] op_sel_hi:[1,0,1]
    v_pk_fma_f32 v[20:21], v[20:21], v[78:79], v[78:79] op_sel:[0,0,1] op_sel_hi:[1,0,1]
    v_pk_fma_f32 v[22:23], v[22:23], v[78:79], v[78:79] op_sel:[0,0,1] op_sel_hi:[1,0,1]
    v_pk_mul_f32 v[8:9], v[8:9], v[144:145]
    v_pk_mul_f32 v[10:11], v[10:11], v[146:147]
    v_pk_mul_f32 v[12:13], v[12:13], v[148:149]
    v_pk_mul_f32 v[14:15], v[14:15], v[150:151]
    v_pk_mul_f32 v[16:17], v[16:17], v[152:153]
    v_pk_mul_f32 v[18:19], v[18:19], v[154:155]
    v_pk_mul_f32 v[20:21], v[20:21], v[156:157]
    v_pk_mul_f32 v[22:23], v[22:23], v[158:159]
    v_exp_f32 v8, v8
    v_exp_f32 v9, v9
    v_exp_f32 v10, v10
    v_exp_f32 v11, v11
    v_exp_f32 v12, v12
    v_exp_f32 v13, v13
    v_exp_f32 v14, v14
    v_exp_f32 v15, v15
    v_exp_f32 v16, v16
    v_exp_f32 v17, v17
    v_exp_f32 v18, v18
    v_exp_f32 v19, v19
    v_exp_f32 v20, v20
    v_exp_f32 v21, v21
    v_exp_f32 v22, v22
    v_exp_f32 v23, v23
    v_pk_fma_f32 v[8:9], v[8:9], v[76:77], v[76:77] op_sel:[0,1,1] op_sel_hi:[1,1,1]
    v_pk_fma_f32 v[10:11], v[10:11], v[76:77], v[76:77] op_sel:[0,1,1] op_sel_hi:[1,1,1]
    v_pk_fma_f32 v[12:13], v[12:13], v[76:77], v[76:77] op_sel:[0,1,1] op_sel_hi:[1,1,1]
    v_pk_fma_f32 v[14:15], v[14:15], v[76:77], v[76:77] op_sel:[0,1,1] op_sel_hi:[1,1,1]
    v_pk_fma_f32 v[16:17], v[16:17], v[76:77], v[76:77] op_sel:[0,1,1] op_sel_hi:[1,1,1]
    v_pk_fma_f32 v[18:19], v[18:19], v[76:77], v[76:77] op_sel:[0,1,1] op_sel_hi:[1,1,1]
    v_pk_fma_f32 v[20:21], v[20:21], v[76:77], v[76:77] op_sel:[0,1,1] op_sel_hi:[1,1,1]
    v_pk_fma_f32 v[22:23], v[22:23], v[76:77], v[76:77] op_sel:[0,1,1] op_sel_hi:[1,1,1]
    v_rcp_f32 v8, v8
    v_rcp_f32 v9, v9
    v_rcp_f32 v10, v10
    v_rcp_f32 v11, v11
    v_rcp_f32 v12, v12
    v_rcp_f32 v13, v13
    v_rcp_f32 v14, v14
    v_rcp_f32 v15, v15
    v_rcp_f32 v16, v16
    v_rcp_f32 v17, v17
    v_rcp_f32 v18, v18
    v_rcp_f32 v19, v19
    v_rcp_f32 v20, v20
    v_rcp_f32 v21, v21
    v_rcp_f32 v22, v22
    v_rcp_f32 v23, v23
    v_pk_mul_f32 v[8:9], v[8:9], v[144:145]
    v_pk_mul_f32 v[10:11], v[10:11], v[146:147]
    v_pk_mul_f32 v[12:13], v[12:13], v[148:149]
    v_pk_mul_f32 v[14:15], v[14:15], v[150:151]
    v_pk_mul_f32 v[16:17], v[16:17], v[152:153]
    v_pk_mul_f32 v[18:19], v[18:19], v[154:155]
    v_pk_mul_f32 v[20:21], v[20:21], v[156:157]
    v_pk_mul_f32 v[22:23], v[22:23], v[158:159]
    v_cvt_pk_bf16_f32 v56, v8, v9
    v_cvt_pk_bf16_f32 v57, v10, v11
    v_cvt_pk_bf16_f32 v58, v12, v13
    v_cvt_pk_bf16_f32 v59, v14, v15
    v_cvt_pk_bf16_f32 v60, v16, v17
    v_cvt_pk_bf16_f32 v61, v18, v19
    v_cvt_pk_bf16_f32 v62, v20, v21
    v_cvt_pk_bf16_f32 v63, v22, v23
    buffer_store_dwordx4 v[56:59], v4, s[16:19], s51 offen offset:0 sc1
    buffer_store_dwordx4 v[60:63], v4, s[16:19], s51 offen offset:1024 sc1
    v_pk_mul_f32 v[8:9], v[160:161], v[160:161]
    v_pk_mul_f32 v[10:11], v[162:163], v[162:163]
    v_pk_mul_f32 v[12:13], v[164:165], v[164:165]
    v_pk_mul_f32 v[14:15], v[166:167], v[166:167]
    v_pk_mul_f32 v[16:17], v[168:169], v[168:169]
    v_pk_mul_f32 v[18:19], v[170:171], v[170:171]
    v_pk_mul_f32 v[20:21], v[172:173], v[172:173]
    v_pk_mul_f32 v[22:23], v[174:175], v[174:175]
    v_pk_fma_f32 v[8:9], v[8:9], v[74:75], v[74:75] op_sel:[0,0,1] op_sel_hi:[1,0,1]
    v_pk_fma_f32 v[10:11], v[10:11], v[74:75], v[74:75] op_sel:[0,0,1] op_sel_hi:[1,0,1]
    v_pk_fma_f32 v[12:13], v[12:13], v[74:75], v[74:75] op_sel:[0,0,1] op_sel_hi:[1,0,1]
    v_pk_fma_f32 v[14:15], v[14:15], v[74:75], v[74:75] op_sel:[0,0,1] op_sel_hi:[1,0,1]
    v_pk_fma_f32 v[16:17], v[16:17], v[74:75], v[74:75] op_sel:[0,0,1] op_sel_hi:[1,0,1]
    v_pk_fma_f32 v[18:19], v[18:19], v[74:75], v[74:75] op_sel:[0,0,1] op_sel_hi:[1,0,1]
    v_pk_fma_f32 v[20:21], v[20:21], v[74:75], v[74:75] op_sel:[0,0,1] op_sel_hi:[1,0,1]
    v_pk_fma_f32 v[22:23], v[22:23], v[74:75], v[74:75] op_sel:[0,0,1] op_sel_hi:[1,0,1]
    v_pk_mul_f32 v[8:9], v[8:9], v[160:161]
    v_pk_mul_f32 v[10:11], v[10:11], v[162:163]
    v_pk_mul_f32 v[12:13], v[12:13], v[164:165]
    v_pk_mul_f32 v[14:15], v[14:15], v[166:167]
    v_pk_mul_f32 v[16:17], v[16:17], v[168:169]
    v_pk_mul_f32 v[18:19], v[18:19], v[170:171]
    v_pk_mul_f32 v[20:21], v[20:21], v[172:173]
    v_pk_mul_f32 v[22:23], v[22:23], v[174:175]
    v_exp_f32 v8, v8
    v_exp_f32 v9, v9
    v_exp_f32 v10, v10
    v_exp_f32 v11, v11
    v_exp_f32 v12, v12
    v_exp_f32 v13, v13
    v_exp_f32 v14, v14
    v_exp_f32 v15, v15
    v_exp_f32 v16, v16
    v_exp_f32 v17, v17
    v_exp_f32 v18, v18
    v_exp_f32 v19, v19
    v_exp_f32 v20, v20
    v_exp_f32 v21, v21
    v_exp_f32 v22, v22
    v_exp_f32 v23, v23
    v_pk_fma_f32 v[8:9], v[8:9], v[72:73], v[72:73] op_sel:[0,1,1] op_sel_hi:[1,1,1]
    v_pk_fma_f32 v[10:11], v[10:11], v[72:73], v[72:73] op_sel:[0,1,1] op_sel_hi:[1,1,1]
    v_pk_fma_f32 v[12:13], v[12:13], v[72:73], v[72:73] op_sel:[0,1,1] op_sel_hi:[1,1,1]
    v_pk_fma_f32 v[14:15], v[14:15], v[72:73], v[72:73] op_sel:[0,1,1] op_sel_hi:[1,1,1]
    v_pk_fma_f32 v[16:17], v[16:17], v[72:73], v[72:73] op_sel:[0,1,1] op_sel_hi:[1,1,1]
    v_pk_fma_f32 v[18:19], v[18:19], v[72:73], v[72:73] op_sel:[0,1,1] op_sel_hi:[1,1,1]
    v_pk_fma_f32 v[20:21], v[20:21], v[72:73], v[72:73] op_sel:[0,1,1] op_sel_hi:[1,1,1]
    v_pk_fma_f32 v[22:23], v[22:23], v[72:73], v[72:73] op_sel:[0,1,1] op_sel_hi:[1,1,1]
    v_rcp_f32 v8, v8
    v_rcp_f32 v9, v9
    v_rcp_f32 v10, v10
    v_rcp_f32 v11, v11
    v_rcp_f32 v12, v12
    v_rcp_f32 v13, v13
    v_rcp_f32 v14, v14
    v_rcp_f32 v15, v15
    v_rcp_f32 v16, v16
    v_rcp_f32 v17, v17
    v_rcp_f32 v18, v18
    v_rcp_f32 v19, v19
    v_rcp_f32 v20, v20
    v_rcp_f32 v21, v21
    v_rcp_f32 v22, v22
    v_rcp_f32 v23, v23
    v_pk_mul_f32 v[8:9], v[8:9], v[160:161]
    v_pk_mul_f32 v[10:11], v[10:11], v[162:163]
    v_pk_mul_f32 v[12:13], v[12:13], v[164:165]
    v_pk_mul_f32 v[14:15], v[14:15], v[166:167]
    v_pk_mul_f32 v[16:17], v[16:17], v[168:169]
    v_pk_mul_f32 v[18:19], v[18:19], v[170:171]
    v_pk_mul_f32 v[20:21], v[20:21], v[172:173]
    v_pk_mul_f32 v[22:23], v[22:23], v[174:175]
    v_cvt_pk_bf16_f32 v48, v8, v9
    v_cvt_pk_bf16_f32 v49, v10, v11
    v_cvt_pk_bf16_f32 v50, v12, v13
    v_cvt_pk_bf16_f32 v51, v14, v15
    v_cvt_pk_bf16_f32 v52, v16, v17
    v_cvt_pk_bf16_f32 v53, v18, v19
    v_cvt_pk_bf16_f32 v54, v20, v21
    v_cvt_pk_bf16_f32 v55, v22, v23
    buffer_store_dwordx4 v[48:51], v4, s[16:19], s48 offen offset:2048 sc1
    buffer_store_dwordx4 v[52:55], v4, s[16:19], s48 offen offset:3072 sc1
    v_pk_mul_f32 v[8:9], v[176:177], v[176:177]
    v_pk_mul_f32 v[10:11], v[178:179], v[178:179]
    v_pk_mul_f32 v[12:13], v[180:181], v[180:181]
    v_pk_mul_f32 v[14:15], v[182:183], v[182:183]
    v_pk_mul_f32 v[16:17], v[184:185], v[184:185]
    v_pk_mul_f32 v[18:19], v[186:187], v[186:187]
    v_pk_mul_f32 v[20:21], v[188:189], v[188:189]
    v_pk_mul_f32 v[22:23], v[190:191], v[190:191]
    v_pk_fma_f32 v[8:9], v[8:9], v[78:79], v[78:79] op_sel:[0,0,1] op_sel_hi:[1,0,1]
    v_pk_fma_f32 v[10:11], v[10:11], v[78:79], v[78:79] op_sel:[0,0,1] op_sel_hi:[1,0,1]
    v_pk_fma_f32 v[12:13], v[12:13], v[78:79], v[78:79] op_sel:[0,0,1] op_sel_hi:[1,0,1]
    v_pk_fma_f32 v[14:15], v[14:15], v[78:79], v[78:79] op_sel:[0,0,1] op_sel_hi:[1,0,1]
    v_pk_fma_f32 v[16:17], v[16:17], v[78:79], v[78:79] op_sel:[0,0,1] op_sel_hi:[1,0,1]
    v_pk_fma_f32 v[18:19], v[18:19], v[78:79], v[78:79] op_sel:[0,0,1] op_sel_hi:[1,0,1]
    v_pk_fma_f32 v[20:21], v[20:21], v[78:79], v[78:79] op_sel:[0,0,1] op_sel_hi:[1,0,1]
    v_pk_fma_f32 v[22:23], v[22:23], v[78:79], v[78:79] op_sel:[0,0,1] op_sel_hi:[1,0,1]
    v_pk_mul_f32 v[8:9], v[8:9], v[176:177]
    v_pk_mul_f32 v[10:11], v[10:11], v[178:179]
    v_pk_mul_f32 v[12:13], v[12:13], v[180:181]
    v_pk_mul_f32 v[14:15], v[14:15], v[182:183]
    v_pk_mul_f32 v[16:17], v[16:17], v[184:185]
    v_pk_mul_f32 v[18:19], v[18:19], v[186:187]
    v_pk_mul_f32 v[20:21], v[20:21], v[188:189]
    v_pk_mul_f32 v[22:23], v[22:23], v[190:191]
    v_exp_f32 v8, v8
    v_exp_f32 v9, v9
    v_exp_f32 v10, v10
    v_exp_f32 v11, v11
    v_exp_f32 v12, v12
    v_exp_f32 v13, v13
    v_exp_f32 v14, v14
    v_exp_f32 v15, v15
    v_exp_f32 v16, v16
    v_exp_f32 v17, v17
    v_exp_f32 v18, v18
    v_exp_f32 v19, v19
    v_exp_f32 v20, v20
    v_exp_f32 v21, v21
    v_exp_f32 v22, v22
    v_exp_f32 v23, v23
    v_pk_fma_f32 v[8:9], v[8:9], v[76:77], v[76:77] op_sel:[0,1,1] op_sel_hi:[1,1,1]
    v_pk_fma_f32 v[10:11], v[10:11], v[76:77], v[76:77] op_sel:[0,1,1] op_sel_hi:[1,1,1]
    v_pk_fma_f32 v[12:13], v[12:13], v[76:77], v[76:77] op_sel:[0,1,1] op_sel_hi:[1,1,1]
    v_pk_fma_f32 v[14:15], v[14:15], v[76:77], v[76:77] op_sel:[0,1,1] op_sel_hi:[1,1,1]
    v_pk_fma_f32 v[16:17], v[16:17], v[76:77], v[76:77] op_sel:[0,1,1] op_sel_hi:[1,1,1]
    v_pk_fma_f32 v[18:19], v[18:19], v[76:77], v[76:77] op_sel:[0,1,1] op_sel_hi:[1,1,1]
    v_pk_fma_f32 v[20:21], v[20:21], v[76:77], v[76:77] op_sel:[0,1,1] op_sel_hi:[1,1,1]
    v_pk_fma_f32 v[22:23], v[22:23], v[76:77], v[76:77] op_sel:[0,1,1] op_sel_hi:[1,1,1]
    v_rcp_f32 v8, v8
    v_rcp_f32 v9, v9
    v_rcp_f32 v10, v10
    v_rcp_f32 v11, v11
    v_rcp_f32 v12, v12
    v_rcp_f32 v13, v13
    v_rcp_f32 v14, v14
    v_rcp_f32 v15, v15
    v_rcp_f32 v16, v16
    v_rcp_f32 v17, v17
    v_rcp_f32 v18, v18
    v_rcp_f32 v19, v19
    v_rcp_f32 v20, v20
    v_rcp_f32 v21, v21
    v_rcp_f32 v22, v22
    v_rcp_f32 v23, v23
    v_pk_mul_f32 v[8:9], v[8:9], v[176:177]
    v_pk_mul_f32 v[10:11], v[10:11], v[178:179]
    v_pk_mul_f32 v[12:13], v[12:13], v[180:181]
    v_pk_mul_f32 v[14:15], v[14:15], v[182:183]
    v_pk_mul_f32 v[16:17], v[16:17], v[184:185]
    v_pk_mul_f32 v[18:19], v[18:19], v[186:187]
    v_pk_mul_f32 v[20:21], v[20:21], v[188:189]
    v_pk_mul_f32 v[22:23], v[22:23], v[190:191]
    v_cvt_pk_bf16_f32 v56, v8, v9
    v_cvt_pk_bf16_f32 v57, v10, v11
    v_cvt_pk_bf16_f32 v58, v12, v13
    v_cvt_pk_bf16_f32 v59, v14, v15
    v_cvt_pk_bf16_f32 v60, v16, v17
    v_cvt_pk_bf16_f32 v61, v18, v19
    v_cvt_pk_bf16_f32 v62, v20, v21
    v_cvt_pk_bf16_f32 v63, v22, v23
    buffer_store_dwordx4 v[56:59], v4, s[16:19], s51 offen offset:2048 sc1
    buffer_store_dwordx4 v[60:63], v4, s[16:19], s51 offen offset:3072 sc1
    s_lshl_b32 s53, s4, 5
    s_and_b32 s54, s5, 7
    s_lshl_b32 s54, s54, 2
    s_add_u32 s53, s53, s54
    s_add_u32 s53, s53, s3
    s_lshl_b32 s53, s53, 2
    s_add_u32 s53, s53, 8066048
    v_mov_b32 v24, s59
    v_mov_b32 v25, 0
    s_waitcnt vmcnt(4)
    s_mov_b64 exec, 1
    buffer_store_dword v24, v25, s[16:19], s53 offen sc1
    s_mov_b64 exec, -1
    s_cmp_lt_u32 s52, 3
    s_cbranch_scc1 K1_END
    v_pk_mul_f32 v[8:9], v[192:193], v[192:193]
    v_pk_mul_f32 v[10:11], v[194:195], v[194:195]
    v_pk_mul_f32 v[12:13], v[196:197], v[196:197]
    v_pk_mul_f32 v[14:15], v[198:199], v[198:199]
    v_pk_mul_f32 v[16:17], v[200:201], v[200:201]
    v_pk_mul_f32 v[18:19], v[202:203], v[202:203]
    v_pk_mul_f32 v[20:21], v[204:205], v[204:205]
    v_pk_mul_f32 v[22:23], v[206:207], v[206:207]
    v_pk_fma_f32 v[8:9], v[8:9], v[74:75], v[74:75] op_sel:[0,0,1] op_sel_hi:[1,0,1]
    v_pk_fma_f32 v[10:11], v[10:11], v[74:75], v[74:75] op_sel:[0,0,1] op_sel_hi:[1,0,1]
    v_pk_fma_f32 v[12:13], v[12:13], v[74:75], v[74:75] op_sel:[0,0,1] op_sel_hi:[1,0,1]
    v_pk_fma_f32 v[14:15], v[14:15], v[74:75], v[74:75] op_sel:[0,0,1] op_sel_hi:[1,0,1]
    v_pk_fma_f32 v[16:17], v[16:17], v[74:75], v[74:75] op_sel:[0,0,1] op_sel_hi:[1,0,1]
    v_pk_fma_f32 v[18:19], v[18:19], v[74:75], v[74:75] op_sel:[0,0,1] op_sel_hi:[1,0,1]
    v_pk_fma_f32 v[20:21], v[20:21], v[74:75], v[74:75] op_sel:[0,0,1] op_sel_hi:[1,0,1]
    v_pk_fma_f32 v[22:23], v[22:23], v[74:75], v[74:75] op_sel:[0,0,1] op_sel_hi:[1,0,1]
    v_pk_mul_f32 v[8:9], v[8:9], v[192:193]
    v_pk_mul_f32 v[10:11], v[10:11], v[194:195]
    v_pk_mul_f32 v[12:13], v[12:13], v[196:197]
    v_pk_mul_f32 v[14:15], v[14:15], v[198:199]
    v_pk_mul_f32 v[16:17], v[16:17], v[200:201]
    v_pk_mul_f32 v[18:19], v[18:19], v[202:203]
    v_pk_mul_f32 v[20:21], v[20:21], v[204:205]
    v_pk_mul_f32 v[22:23], v[22:23], v[206:207]
    v_exp_f32 v8, v8
    v_exp_f32 v9, v9
    v_exp_f32 v10, v10
    v_exp_f32 v11, v11
    v_exp_f32 v12, v12
    v_exp_f32 v13, v13
    v_exp_f32 v14, v14
    v_exp_f32 v15, v15
    v_exp_f32 v16, v16
    v_exp_f32 v17, v17
    v_exp_f32 v18, v18
    v_exp_f32 v19, v19
    v_exp_f32 v20, v20
    v_exp_f32 v21, v21
    v_exp_f32 v22, v22
    v_exp_f32 v23, v23
    v_pk_fma_f32 v[8:9], v[8:9], v[72:73], v[72:73] op_sel:[0,1,1] op_sel_hi:[1,1,1]
    v_pk_fma_f32 v[10:11], v[10:11], v[72:73], v[72:73] op_sel:[0,1,1] op_sel_hi:[1,1,1]
    v_pk_fma_f32 v[12:13], v[12:13], v[72:73], v[72:73] op_sel:[0,1,1] op_sel_hi:[1,1,1]
    v_pk_fma_f32 v[14:15], v[14:15], v[72:73], v[72:73] op_sel:[0,1,1] op_sel_hi:[1,1,1]
    v_pk_fma_f32 v[16:17], v[16:17], v[72:73], v[72:73] op_sel:[0,1,1] op_sel_hi:[1,1,1]
    v_pk_fma_f32 v[18:19], v[18:19], v[72:73], v[72:73] op_sel:[0,1,1] op_sel_hi:[1,1,1]
    v_pk_fma_f32 v[20:21], v[20:21], v[72:73], v[72:73] op_sel:[0,1,1] op_sel_hi:[1,1,1]
    v_pk_fma_f32 v[22:23], v[22:23], v[72:73], v[72:73] op_sel:[0,1,1] op_sel_hi:[1,1,1]
    v_rcp_f32 v8, v8
    v_rcp_f32 v9, v9
    v_rcp_f32 v10, v10
    v_rcp_f32 v11, v11
    v_rcp_f32 v12, v12
    v_rcp_f32 v13, v13
    v_rcp_f32 v14, v14
    v_rcp_f32 v15, v15
    v_rcp_f32 v16, v16
    v_rcp_f32 v17, v17
    v_rcp_f32 v18, v18
    v_rcp_f32 v19, v19
    v_rcp_f32 v20, v20
    v_rcp_f32 v21, v21
    v_rcp_f32 v22, v22
    v_rcp_f32 v23, v23
    v_pk_mul_f32 v[8:9], v[8:9], v[192:193]
    v_pk_mul_f32 v[10:11], v[10:11], v[194:195]
    v_pk_mul_f32 v[12:13], v[12:13], v[196:197]
    v_pk_mul_f32 v[14:15], v[14:15], v[198:199]
    v_pk_mul_f32 v[16:17], v[16:17], v[200:201]
    v_pk_mul_f32 v[18:19], v[18:19], v[202:203]
    v_pk_mul_f32 v[20:21], v[20:21], v[204:205]
    v_pk_mul_f32 v[22:23], v[22:23], v[206:207]
    v_cvt_pk_bf16_f32 v48, v8, v9
    v_cvt_pk_bf16_f32 v49, v10, v11
    v_cvt_pk_bf16_f32 v50, v12, v13
    v_cvt_pk_bf16_f32 v51, v14, v15
    v_cvt_pk_bf16_f32 v52, v16, v17
    v_cvt_pk_bf16_f32 v53, v18, v19
    v_cvt_pk_bf16_f32 v54, v20, v21
    v_cvt_pk_bf16_f32 v55, v22, v23
    s_add_u32 s53, s48, 4096
    buffer_store_dwordx4 v[48:51], v4, s[16:19], s53 offen offset:0 sc1
    buffer_store_dwordx4 v[52:55], v4, s[16:19], s53 offen offset:1024 sc1
    v_pk_mul_f32 v[8:9], v[208:209], v[208:209]
    v_pk_mul_f32 v[10:11], v[210:211], v[210:211]
    v_pk_mul_f32 v[12:13], v[212:213], v[212:213]
    v_pk_mul_f32 v[14:15], v[214:215], v[214:215]
    v_pk_mul_f32 v[16:17], v[216:217], v[216:217]
    v_pk_mul_f32 v[18:19], v[218:219], v[218:219]
    v_pk_mul_f32 v[20:21], v[220:221], v[220:221]
    v_pk_mul_f32 v[22:23], v[222:223], v[222:223]
    v_pk_fma_f32 v[8:9], v[8:9], v[78:79], v[78:79] op_sel:[0,0,1] op_sel_hi:[1,0,1]
    v_pk_fma_f32 v[10:11], v[10:11], v[78:79], v[78:79] op_sel:[0,0,1] op_sel_hi:[1,0,1]
    v_pk_fma_f32 v[12:13], v[12:13], v[78:79], v[78:79] op_sel:[0,0,1] op_sel_hi:[1,0,1]
    v_pk_fma_f32 v[14:15], v[14:15], v[78:79], v[78:79] op_sel:[0,0,1] op_sel_hi:[1,0,1]
    v_pk_fma_f32 v[16:17], v[16:17], v[78:79], v[78:79] op_sel:[0,0,1] op_sel_hi:[1,0,1]
    v_pk_fma_f32 v[18:19], v[18:19], v[78:79], v[78:79] op_sel:[0,0,1] op_sel_hi:[1,0,1]
    v_pk_fma_f32 v[20:21], v[20:21], v[78:79], v[78:79] op_sel:[0,0,1] op_sel_hi:[1,0,1]
    v_pk_fma_f32 v[22:23], v[22:23], v[78:79], v[78:79] op_sel:[0,0,1] op_sel_hi:[1,0,1]
    v_pk_mul_f32 v[8:9], v[8:9], v[208:209]
    v_pk_mul_f32 v[10:11], v[10:11], v[210:211]
    v_pk_mul_f32 v[12:13], v[12:13], v[212:213]
    v_pk_mul_f32 v[14:15], v[14:15], v[214:215]
    v_pk_mul_f32 v[16:17], v[16:17], v[216:217]
    v_pk_mul_f32 v[18:19], v[18:19], v[218:219]
    v_pk_mul_f32 v[20:21], v[20:21], v[220:221]
    v_pk_mul_f32 v[22:23], v[22:23], v[222:223]
    v_exp_f32 v8, v8
    v_exp_f32 v9, v9
    v_exp_f32 v10, v10
    v_exp_f32 v11, v11
    v_exp_f32 v12, v12
    v_exp_f32 v13, v13
    v_exp_f32 v14, v14
    v_exp_f32 v15, v15
    v_exp_f32 v16, v16
    v_exp_f32 v17, v17
    v_exp_f32 v18, v18
    v_exp_f32 v19, v19
    v_exp_f32 v20, v20
    v_exp_f32 v21, v21
    v_exp_f32 v22, v22
    v_exp_f32 v23, v23
    v_pk_fma_f32 v[8:9], v[8:9], v[76:77], v[76:77] op_sel:[0,1,1] op_sel_hi:[1,1,1]
    v_pk_fma_f32 v[10:11], v[10:11], v[76:77], v[76:77] op_sel:[0,1,1] op_sel_hi:[1,1,1]
    v_pk_fma_f32 v[12:13], v[12:13], v[76:77], v[76:77] op_sel:[0,1,1] op_sel_hi:[1,1,1]
    v_pk_fma_f32 v[14:15], v[14:15], v[76:77], v[76:77] op_sel:[0,1,1] op_sel_hi:[1,1,1]
    v_pk_fma_f32 v[16:17], v[16:17], v[76:77], v[76:77] op_sel:[0,1,1] op_sel_hi:[1,1,1]
    v_pk_fma_f32 v[18:19], v[18:19], v[76:77], v[76:77] op_sel:[0,1,1] op_sel_hi:[1,1,1]
    v_pk_fma_f32 v[20:21], v[20:21], v[76:77], v[76:77] op_sel:[0,1,1] op_sel_hi:[1,1,1]
    v_pk_fma_f32 v[22:23], v[22:23], v[76:77], v[76:77] op_sel:[0,1,1] op_sel_hi:[1,1,1]
    v_rcp_f32 v8, v8
    v_rcp_f32 v9, v9
    v_rcp_f32 v10, v10
    v_rcp_f32 v11, v11
    v_rcp_f32 v12, v12
    v_rcp_f32 v13, v13
    v_rcp_f32 v14, v14
    v_rcp_f32 v15, v15
    v_rcp_f32 v16, v16
    v_rcp_f32 v17, v17
    v_rcp_f32 v18, v18
    v_rcp_f32 v19, v19
    v_rcp_f32 v20, v20
    v_rcp_f32 v21, v21
    v_rcp_f32 v22, v22
    v_rcp_f32 v23, v23
    v_pk_mul_f32 v[8:9], v[8:9], v[208:209]
    v_pk_mul_f32 v[10:11], v[10:11], v[210:211]
    v_pk_mul_f32 v[12:13], v[12:13], v[212:213]
    v_pk_mul_f32 v[14:15], v[14:15], v[214:215]
    v_pk_mul_f32 v[16:17], v[16:17], v[216:217]
    v_pk_mul_f32 v[18:19], v[18:19], v[218:219]
    v_pk_mul_f32 v[20:21], v[20:21], v[220:221]
    v_pk_mul_f32 v[22:23], v[22:23], v[222:223]
    v_cvt_pk_bf16_f32 v56, v8, v9
    v_cvt_pk_bf16_f32 v57, v10, v11
    v_cvt_pk_bf16_f32 v58, v12, v13
    v_cvt_pk_bf16_f32 v59, v14, v15
    v_cvt_pk_bf16_f32 v60, v16, v17
    v_cvt_pk_bf16_f32 v61, v18, v19
    v_cvt_pk_bf16_f32 v62, v20, v21
    v_cvt_pk_bf16_f32 v63, v22, v23
    s_add_u32 s53, s51, 4096
    buffer_store_dwordx4 v[56:59], v4, s[16:19], s53 offen offset:0 sc1
    buffer_store_dwordx4 v[60:63], v4, s[16:19], s53 offen offset:1024 sc1
    s_branch K1_END
K2_LENTRY:
    s_mov_b32 s30, s82
    s_mov_b32 s31, s83
    s_mov_b32 s32, s84
    s_mov_b32 s33, s85
    s_mov_b32 s34, s92
    s_mov_b32 s35, s93
    s_mov_b32 s36, s94
    s_mov_b32 s37, s95
    s_and_b32 s8, s2, 7
    s_lshr_b32 s9, s2, 3
    s_and_b32 s4, s9, 3
    s_lshl_b32 s8, s8, 2
    s_add_u32 s4, s4, s8
    s_lshr_b32 s5, s9, 2
    s_mov_b32 s40, 21760
    s_mov_b32 s64, 32768
    s_mov_b32 s65, 0xffff0000
    s_and_b32 s46, s3, 3
    s_lshl_b32 s45, s4, 1
    s_mul_i32 s47, s45, 88064
    s_lshl_b32 s48, s45, 15
    s_add_u32 s48, s48, 5636096
    s_lshl_b32 s49, s46, 11
    s_add_u32 s48, s48, s49
    v_lshlrev_b32 v3, 4, v2
    v_lshrrev_b32 v4, 3, v2
    v_and_b32 v5, 7, v2
    v_bfe_u32 v6, v2, 4, 1
    v_lshlrev_b32 v6, 2, v6
    v_xor_b32 v5, v5, v6
    v_lshlrev_b32 v5, 4, v5
    v_lshl_add_u32 v4, v4, 10, v5
    s_lshl_b32 s49, s5, 7
    v_add_u32 v4, s49, v4
    v_add_u32 v5, 0x2000, v4
    v_add_u32 v6, 0x4000, v4
    v_add_u32 v7, 0x6000, v4
    s_lshl_b32 s54, s46, 11
    s_lshl_b32 s55, s46, 12
    s_add_u32 s55, s55, 16384
    s_mov_b32 s15, 0x20000
    s_mov_b32 s8, s38
    s_and_b32 s9, s39, 0xffff
    s_mov_b32 s10, 8072192
    s_mov_b32 s11, 0x20000
    s_mov_b32 s20, s28
    s_and_b32 s21, s29, 0xffff
    s_mov_b32 s22, 2097152
    s_mov_b32 s23, 0x20000
    s_mov_b32 s24, s34
    s_and_b32 s25, s35, 0xffff
    s_mov_b32 s26, 1024
    s_mov_b32 s27, 0x20000
    s_mov_b32 s41, 0
    s_mov_b32 s42, 0
    s_mov_b32 s52, 0
    s_mov_b32 s53, 0
    s_mov_b32 s51, 3
K2_PB:
    s_add_u32 s58, s53, s54
    s_add_u32 s59, s53, s55
    s_bitcmp1_b32 s40, s52
    s_cbranch_scc1 K2_AD_1A
    s_lshl_b32 s56, s41, 2
    s_add_u32 s56, s56, s46
    s_and_b32 s57, s56, 1
    s_mul_i32 s57, s57, 3
    s_lshr_b32 s60, s56, 4
    s_add_u32 s57, s57, s60
    s_and_b32 s61, s56, 15
    s_lshr_b32 s61, s61, 1
    s_cmp_lt_u32 s56, 38
    s_cbranch_scc1 K2_AD_1T
    s_sub_u32 s61, s56, 35
    s_mov_b32 s57, 2
K2_AD_1T:
    s_mul_i32 s62, s61, 6
    s_mul_i32 s61, s61, 5
    s_add_u32 s61, s61, 3
    s_min_u32 s61, s61, s62
    s_add_u32 s61, s61, s57
    s_cmp_eq_u32 s56, 43
    s_cselect_b32 s61, 43, s61
    s_lshl_b32 s56, s61, 11
    s_add_u32 s56, s56, s47
    s_add_u32 s57, s56, 88064
    s_lshl_b32 s60, s61, 15
    s_add_u32 s41, s41, 1
    s_mov_b32 s12, s32
    s_and_b32 s13, s33, 0xffff
    s_mov_b32 s14, 1409024
    s_branch K2_AD_1E
K2_AD_1A:
    s_lshl_b32 s56, s42, 13
    s_add_u32 s56, s56, s48
    s_add_u32 s57, s56, 32768
    s_lshl_b32 s60, s42, 17
    s_lshl_b32 s61, s46, 15
    s_add_u32 s60, s60, s61
    s_add_u32 s42, s42, 1
    s_mov_b32 s12, s30
    s_and_b32 s13, s31, 0xffff
    s_mov_b32 s14, 524288
K2_AD_1E:
    s_add_u32 s52, s52, 1
    s_add_u32 s53, s53, s64
    s_cmp_eq_u32 s53, 98304
    s_cselect_b32 s53, 0, s53
    s_mov_b32 m0, s59
    s_nop 0
    buffer_load_dwordx4 v4, s[12:15], s60 offen lds
    s_add_u32 m0, s59, 1024
    s_nop 0
    buffer_load_dwordx4 v5, s[12:15], s60 offen lds
    s_add_u32 m0, s59, 2048
    s_nop 0
    buffer_load_dwordx4 v6, s[12:15], s60 offen lds
    s_add_u32 m0, s59, 3072
    s_nop 0
    buffer_load_dwordx4 v7, s[12:15], s60 offen lds
    s_sub_u32 s51, s51, 1
    s_cmp_lg_u32 s51, 0
    s_cbranch_scc1 K2_PB
    v_mov_b32 v26, 122912
    s_mov_b32 s61, 0x40000
    s_cmp_lg_u32 s46, 0
    s_cbranch_scc1 K2_GW
    s_lshr_b32 s62, s4, 1
    s_lshl_b32 s62, s62, 7
    s_add_u32 s62, s62, 8066048
    v_and_b32 v25, 31, v2
    v_lshlrev_b32 v25, 2, v25
    s_sleep 48
    buffer_load_dword v24, v25, s[8:11], s62 offen sc1
    s_sleep 5
    buffer_load_dword v27, v25, s[8:11], s62 offen sc1
    s_sleep 5
    buffer_load_dword v28, v25, s[8:11], s62 offen sc1
K2_GP:
    s_waitcnt vmcnt(2)
    v_cmp_ne_u32 vcc, s63, v24
    s_sub_u32 s61, s61, 1
    s_cmp_eq_u32 s61, 0
    s_cbranch_scc1 K2_GD
    s_cbranch_vccz K2_GD
    buffer_load_dword v24, v25, s[8:11], s62 offen sc1
    s_waitcnt vmcnt(2)
    v_cmp_ne_u32 vcc, s63, v27
    s_nop 2
    s_cbranch_vccz K2_GD
    buffer_load_dword v27, v25, s[8:11], s62 offen sc1
    s_waitcnt vmcnt(2)
    v_cmp_ne_u32 vcc, s63, v28
    s_nop 2
    s_cbranch_vccz K2_GD
    buffer_load_dword v28, v25, s[8:11], s62 offen sc1
    s_branch K2_GP
K2_GD:
    v_mov_b32 v29, s63
    ds_write_b32 v26, v29
    s_branch K2_GE
K2_GW:
    ds_read_b32 v24, v26
    s_waitcnt lgkmcnt(0)
    v_readfirstlane_b32 s62, v24
    s_sub_u32 s61, s61, 1
    s_cmp_eq_u32 s62, s63
    s_cbranch_scc1 K2_GE
    s_sleep 2
    s_cmp_lg_u32 s61, 0
    s_cbranch_scc1 K2_GW
K2_GE:
    s_mov_b32 s41, 0
    s_mov_b32 s42, 0
    s_mov_b32 s52, 0
    s_mov_b32 s53, 0
    s_mov_b32 s51, 3
K2_PA:
    s_add_u32 s58, s53, s54
    s_add_u32 s59, s53, s55
    s_bitcmp1_b32 s40, s52
    s_cbranch_scc1 K2_AD_2A
    s_lshl_b32 s56, s41, 2
    s_add_u32 s56, s56, s46
    s_and_b32 s57, s56, 1
    s_mul_i32 s57, s57, 3
    s_lshr_b32 s60, s56, 4
    s_add_u32 s57, s57, s60
    s_and_b32 s61, s56, 15
    s_lshr_b32 s61, s61, 1
    s_cmp_lt_u32 s56, 38
    s_cbranch_scc1 K2_AD_2T
    s_sub_u32 s61, s56, 35
    s_mov_b32 s57, 2
K2_AD_2T:
    s_mul_i32 s62, s61, 6
    s_mul_i32 s61, s61, 5
    s_add_u32 s61, s61, 3
    s_min_u32 s61, s61, s62
    s_add_u32 s61, s61, s57
    s_cmp_eq_u32 s56, 43
    s_cselect_b32 s61, 43, s61
    s_lshl_b32 s56, s61, 11
    s_add_u32 s56, s56, s47
    s_add_u32 s57, s56, 88064
    s_lshl_b32 s60, s61, 15
    s_add_u32 s41, s41, 1
    s_mov_b32 s12, s32
    s_and_b32 s13, s33, 0xffff
    s_mov_b32 s14, 1409024
    s_branch K2_AD_2E
K2_AD_2A:
    s_lshl_b32 s56, s42, 13
    s_add_u32 s56, s56, s48
    s_add_u32 s57, s56, 32768
    s_lshl_b32 s60, s42, 17
    s_lshl_b32 s61, s46, 15
    s_add_u32 s60, s60, s61
    s_add_u32 s42, s42, 1
    s_mov_b32 s12, s30
    s_and_b32 s13, s31, 0xffff
    s_mov_b32 s14, 524288
K2_AD_2E:
    s_add_u32 s52, s52, 1
    s_add_u32 s53, s53, s64
    s_cmp_eq_u32 s53, 98304
    s_cselect_b32 s53, 0, s53
    s_mov_b32 m0, s58
    s_nop 0
    buffer_load_dwordx4 v3, s[8:11], s56 offen sc1 lds
    buffer_load_dwordx4 v3, s[8:11], s56 offen offset:1024 sc1 lds
    s_add_u32 m0, s58, 8192
    s_nop 0
    buffer_load_dwordx4 v3, s[8:11], s57 offen sc1 lds
    buffer_load_dwordx4 v3, s[8:11], s57 offen offset:1024 sc1 lds
    s_sub_u32 s51, s51, 1
    s_cmp_lg_u32 s51, 0
    s_cbranch_scc1 K2_PA
    s_add_u32 s58, s53, s54
    s_add_u32 s59, s53, s55
    s_bitcmp1_b32 s40, s52
    s_cbranch_scc1 K2_AD_3A
    s_lshl_b32 s56, s41, 2
    s_add_u32 s56, s56, s46
    s_and_b32 s57, s56, 1
    s_mul_i32 s57, s57, 3
    s_lshr_b32 s60, s56, 4
    s_add_u32 s57, s57, s60
    s_and_b32 s61, s56, 15
    s_lshr_b32 s61, s61, 1
    s_cmp_lt_u32 s56, 38
    s_cbranch_scc1 K2_AD_3T
    s_sub_u32 s61, s56, 35
    s_mov_b32 s57, 2
K2_AD_3T:
    s_mul_i32 s62, s61, 6
    s_mul_i32 s61, s61, 5
    s_add_u32 s61, s61, 3
    s_min_u32 s61, s61, s62
    s_add_u32 s61, s61, s57
    s_cmp_eq_u32 s56, 43
    s_cselect_b32 s61, 43, s61
    s_lshl_b32 s56, s61, 11
    s_add_u32 s56, s56, s47
    s_add_u32 s57, s56, 88064
    s_lshl_b32 s60, s61, 15
    s_add_u32 s41, s41, 1
    s_mov_b32 s12, s32
    s_and_b32 s13, s33, 0xffff
    s_mov_b32 s14, 1409024
    s_branch K2_AD_3E
K2_AD_3A:
    s_lshl_b32 s56, s42, 13
    s_add_u32 s56, s56, s48
    s_add_u32 s57, s56, 32768
    s_lshl_b32 s60, s42, 17
    s_lshl_b32 s61, s46, 15
    s_add_u32 s60, s60, s61
    s_add_u32 s42, s42, 1
    s_mov_b32 s12, s30
    s_and_b32 s13, s31, 0xffff
    s_mov_b32 s14, 524288
K2_AD_3E:
    s_add_u32 s52, s52, 1
    s_add_u32 s53, s53, s64
    s_cmp_eq_u32 s53, 98304
    s_cselect_b32 s53, 0, s53
    s_waitcnt vmcnt(8)
    s_barrier
    s_lshr_b32 s86, s4, 1
    s_lshl_b32 s86, s86, 7
    s_add_u32 s86, s86, 8068096
    v_and_b32 v25, 31, v2
    v_lshlrev_b32 v25, 2, v25
    s_cmp_lg_u32 s46, 0
    s_cbranch_scc1 K2_NL1
    buffer_load_dword v24, v25, s[8:11], s86 offen sc1
K2_NL1:
    s_mov_b32 s88, s56
    s_mov_b32 s89, s57
    v_lshrrev_b32 v8, 3, v2
    v_and_b32 v9, 7, v2
    v_xor_b32 v9, v9, v8
    v_lshlrev_b32 v9, 4, v9
    v_lshl_add_u32 v9, v8, 10, v9
    s_lshl_b32 s56, s4, 16
    s_lshl_b32 s57, s5, 7
    s_add_u32 s56, s56, s57
    s_lshl_b32 s57, s46, 14
    s_add_u32 s56, s56, s57
    s_lshl_b32 s57, s46, 11
    s_add_u32 m0, s57, 133120
    s_nop 0
    buffer_load_dwordx4 v9, s[20:23], s56 offen lds
    s_add_u32 m0, s57, 134144
    s_add_u32 s56, s56, 8192
    buffer_load_dwordx4 v9, s[20:23], s56 offen lds
    v_and_b32 v8, 7, v2
    v_lshlrev_b32 v8, 4, v8
    s_lshl_b32 s56, s5, 7
    s_mov_b32 m0, 141312
    s_nop 0
    buffer_load_dwordx4 v8, s[24:27], s56 offen lds
    s_mov_b32 s56, s88
    s_mov_b32 s57, s89
    s_waitcnt vmcnt(7)
    s_barrier
    s_mov_b32 m0, s58
    s_nop 0
    buffer_load_dwordx4 v3, s[8:11], s56 offen sc1 lds
    buffer_load_dwordx4 v3, s[8:11], s56 offen offset:1024 sc1 lds
    s_add_u32 m0, s58, 8192
    s_nop 0
    buffer_load_dwordx4 v3, s[8:11], s57 offen sc1 lds
    buffer_load_dwordx4 v3, s[8:11], s57 offen offset:1024 sc1 lds
    s_mov_b32 m0, s59
    s_nop 0
    buffer_load_dwordx4 v4, s[12:15], s60 offen lds
    s_add_u32 m0, s59, 1024
    s_nop 0
    buffer_load_dwordx4 v5, s[12:15], s60 offen lds
    s_add_u32 m0, s59, 2048
    s_nop 0
    buffer_load_dwordx4 v6, s[12:15], s60 offen lds
    s_add_u32 m0, s59, 3072
    s_nop 0
    buffer_load_dwordx4 v7, s[12:15], s60 offen lds
    s_add_u32 s58, s53, s54
    s_add_u32 s59, s53, s55
    s_bitcmp1_b32 s40, s52
    s_cbranch_scc1 K2_AD_4A
    s_lshl_b32 s56, s41, 2
    s_add_u32 s56, s56, s46
    s_and_b32 s57, s56, 1
    s_mul_i32 s57, s57, 3
    s_lshr_b32 s60, s56, 4
    s_add_u32 s57, s57, s60
    s_and_b32 s61, s56, 15
    s_lshr_b32 s61, s61, 1
    s_cmp_lt_u32 s56, 38
    s_cbranch_scc1 K2_AD_4T
    s_sub_u32 s61, s56, 35
    s_mov_b32 s57, 2
K2_AD_4T:
    s_mul_i32 s62, s61, 6
    s_mul_i32 s61, s61, 5
    s_add_u32 s61, s61, 3
    s_min_u32 s61, s61, s62
    s_add_u32 s61, s61, s57
    s_cmp_eq_u32 s56, 43
    s_cselect_b32 s61, 43, s61
    s_lshl_b32 s56, s61, 11
    s_add_u32 s56, s56, s47
    s_add_u32 s57, s56, 88064
    s_lshl_b32 s60, s61, 15
    s_add_u32 s41, s41, 1
    s_mov_b32 s12, s32
    s_and_b32 s13, s33, 0xffff
    s_mov_b32 s14, 1409024
    s_branch K2_AD_4E
K2_AD_4A:
    s_lshl_b32 s56, s42, 13
    s_add_u32 s56, s56, s48
    s_add_u32 s57, s56, 32768
    s_lshl_b32 s60, s42, 17
    s_lshl_b32 s61, s46, 15
    s_add_u32 s60, s60, s61
    s_add_u32 s42, s42, 1
    s_mov_b32 s12, s30
    s_and_b32 s13, s31, 0xffff
    s_mov_b32 s14, 524288
K2_AD_4E:
    s_add_u32 s52, s52, 1
    s_add_u32 s53, s53, s64
    s_cmp_eq_u32 s53, 98304
    s_cselect_b32 s53, 0, s53
    s_waitcnt vmcnt(8)
    s_cmp_lg_u32 s46, 0
    s_cbranch_scc1 K2_RD
    s_mov_b32 s61, 0x40000
K2_RP:
    v_cmp_ne_u32 vcc, s63, v24
    s_sub_u32 s61, s61, 1
    s_cmp_eq_u32 s61, 0
    s_cbranch_scc1 K2_RD
    s_cbranch_vccz K2_RD
    s_sleep 4
    buffer_load_dword v24, v25, s[8:11], s86 offen sc1
    s_waitcnt vmcnt(0)
    s_branch K2_RP
K2_RD:
    s_barrier
    s_mov_b32 s85, 8070144
    s_cmp_lg_u32 s46, 0
    s_cbranch_scc1 K2_NL2
    buffer_load_dwordx4 v[36:39], v3, s[8:11], s85 offen sc1
    buffer_load_dwordx4 v[40:43], v3, s[8:11], s85 offen offset:1024 sc1
K2_NL2:
    s_mov_b32 m0, s58
    s_nop 0
    buffer_load_dwordx4 v3, s[8:11], s56 offen sc1 lds
    buffer_load_dwordx4 v3, s[8:11], s56 offen offset:1024 sc1 lds
    s_add_u32 m0, s58, 8192
    s_nop 0
    buffer_load_dwordx4 v3, s[8:11], s57 offen sc1 lds
    buffer_load_dwordx4 v3, s[8:11], s57 offen offset:1024 sc1 lds
    s_mov_b32 m0, s59
    s_nop 0
    buffer_load_dwordx4 v4, s[12:15], s60 offen lds
    s_add_u32 m0, s59, 1024
    s_nop 0
    buffer_load_dwordx4 v5, s[12:15], s60 offen lds
    s_add_u32 m0, s59, 2048
    s_nop 0
    buffer_load_dwordx4 v6, s[12:15], s60 offen lds
    s_add_u32 m0, s59, 3072
    s_nop 0
    buffer_load_dwordx4 v7, s[12:15], s60 offen lds
    s_add_u32 s58, s53, s54
    s_add_u32 s59, s53, s55
    s_bitcmp1_b32 s40, s52
    s_cbranch_scc1 K2_AD_5A
    s_lshl_b32 s56, s41, 2
    s_add_u32 s56, s56, s46
    s_and_b32 s57, s56, 1
    s_mul_i32 s57, s57, 3
    s_lshr_b32 s60, s56, 4
    s_add_u32 s57, s57, s60
    s_and_b32 s61, s56, 15
    s_lshr_b32 s61, s61, 1
    s_cmp_lt_u32 s56, 38
    s_cbranch_scc1 K2_AD_5T
    s_sub_u32 s61, s56, 35
    s_mov_b32 s57, 2
K2_AD_5T:
    s_mul_i32 s62, s61, 6
    s_mul_i32 s61, s61, 5
    s_add_u32 s61, s61, 3
    s_min_u32 s61, s61, s62
    s_add_u32 s61, s61, s57
    s_cmp_eq_u32 s56, 43
    s_cselect_b32 s61, 43, s61
    s_lshl_b32 s56, s61, 11
    s_add_u32 s56, s56, s47
    s_add_u32 s57, s56, 88064
    s_lshl_b32 s60, s61, 15
    s_add_u32 s41, s41, 1
    s_mov_b32 s12, s32
    s_and_b32 s13, s33, 0xffff
    s_mov_b32 s14, 1409024
    s_branch K2_AD_5E
K2_AD_5A:
    s_lshl_b32 s56, s42, 13
    s_add_u32 s56, s56, s48
    s_add_u32 s57, s56, 32768
    s_lshl_b32 s60, s42, 17
    s_lshl_b32 s61, s46, 15
    s_add_u32 s60, s60, s61
    s_add_u32 s42, s42, 1
    s_mov_b32 s12, s30
    s_and_b32 s13, s31, 0xffff
    s_mov_b32 s14, 524288
K2_AD_5E:
    s_add_u32 s52, s52, 1
    s_add_u32 s53, s53, s64
    s_cmp_eq_u32 s53, 98304
    s_cselect_b32 s53, 0, s53
    s_waitcnt vmcnt(8)
    s_barrier
    s_mov_b32 m0, s58
    s_nop 0
    buffer_load_dwordx4 v3, s[8:11], s56 offen sc1 lds
    buffer_load_dwordx4 v3, s[8:11], s56 offen offset:1024 sc1 lds
    s_add_u32 m0, s58, 8192
    s_nop 0
    buffer_load_dwordx4 v3, s[8:11], s57 offen sc1 lds
    buffer_load_dwordx4 v3, s[8:11], s57 offen offset:1024 sc1 lds
    s_mov_b32 m0, s59
    s_nop 0
    buffer_load_dwordx4 v4, s[12:15], s60 offen lds
    s_add_u32 m0, s59, 1024
    s_nop 0
    buffer_load_dwordx4 v5, s[12:15], s60 offen lds
    s_add_u32 m0, s59, 2048
    s_nop 0
    buffer_load_dwordx4 v6, s[12:15], s60 offen lds
    s_add_u32 m0, s59, 3072
    s_nop 0
    buffer_load_dwordx4 v7, s[12:15], s60 offen lds
    s_add_u32 s58, s53, s54
    s_add_u32 s59, s53, s55
    s_bitcmp1_b32 s40, s52
    s_cbranch_scc1 K2_AD_6A
    s_lshl_b32 s56, s41, 2
    s_add_u32 s56, s56, s46
    s_and_b32 s57, s56, 1
    s_mul_i32 s57, s57, 3
    s_lshr_b32 s60, s56, 4
    s_add_u32 s57, s57, s60
    s_and_b32 s61, s56, 15
    s_lshr_b32 s61, s61, 1
    s_cmp_lt_u32 s56, 38
    s_cbranch_scc1 K2_AD_6T
    s_sub_u32 s61, s56, 35
    s_mov_b32 s57, 2
K2_AD_6T:
    s_mul_i32 s62, s61, 6
    s_mul_i32 s61, s61, 5
    s_add_u32 s61, s61, 3
    s_min_u32 s61, s61, s62
    s_add_u32 s61, s61, s57
    s_cmp_eq_u32 s56, 43
    s_cselect_b32 s61, 43, s61
    s_lshl_b32 s56, s61, 11
    s_add_u32 s56, s56, s47
    s_add_u32 s57, s56, 88064
    s_lshl_b32 s60, s61, 15
    s_add_u32 s41, s41, 1
    s_mov_b32 s12, s32
    s_and_b32 s13, s33, 0xffff
    s_mov_b32 s14, 1409024
    s_branch K2_AD_6E
K2_AD_6A:
    s_lshl_b32 s56, s42, 13
    s_add_u32 s56, s56, s48
    s_add_u32 s57, s56, 32768
    s_lshl_b32 s60, s42, 17
    s_lshl_b32 s61, s46, 15
    s_add_u32 s60, s60, s61
    s_add_u32 s42, s42, 1
    s_mov_b32 s12, s30
    s_and_b32 s13, s31, 0xffff
    s_mov_b32 s14, 524288
K2_AD_6E:
    s_add_u32 s52, s52, 1
    s_add_u32 s53, s53, s64
    s_cmp_eq_u32 s53, 98304
    s_cselect_b32 s53, 0, s53
    s_waitcnt vmcnt(8)
    s_cmp_lg_u32 s46, 0
    s_cbranch_scc1 K2_PEK
    s_mov_b32 s61, 0x40000
K2_PLK:
    v_xor_b32 v32, s63, v36
    v_xor_b32 v33, s63, v37
    v_or_b32 v32, v32, v33
    v_xor_b32 v33, s63, v38
    v_or_b32 v32, v32, v33
    v_xor_b32 v33, s63, v39
    v_or_b32 v32, v32, v33
    v_xor_b32 v33, s63, v40
    v_or_b32 v32, v32, v33
    v_xor_b32 v33, s63, v41
    v_or_b32 v32, v32, v33
    v_xor_b32 v33, s63, v42
    v_or_b32 v32, v32, v33
    v_xor_b32 v33, s63, v43
    v_or_b32 v32, v32, v33
    v_cmp_ne_u32 vcc, 0, v32
    s_sub_u32 s61, s61, 1
    s_cmp_eq_u32 s61, 0
    s_cbranch_scc1 K2_PEK
    s_cbranch_vccz K2_PEK
    s_sleep 4
    buffer_load_dwordx4 v[36:39], v3, s[8:11], s85 offen sc1
    buffer_load_dwordx4 v[40:43], v3, s[8:11], s85 offen offset:1024 sc1
    s_waitcnt vmcnt(0)
    s_branch K2_PLK
K2_PEK:
    s_barrier
    s_lshl_b32 s61, s46, 13
    s_add_u32 s62, s61, 7733248
    s_add_u32 s61, s61, 98304
    s_add_u32 m0, s61, 0
    s_add_u32 s88, s62, 0
    buffer_load_dwordx4 v3, s[8:11], s88 offen offset:0 sc1 lds
    buffer_load_dwordx4 v3, s[8:11], s88 offen offset:1024 sc1 lds
    buffer_load_dwordx4 v3, s[8:11], s88 offen offset:2048 sc1 lds
    buffer_load_dwordx4 v3, s[8:11], s88 offen offset:3072 sc1 lds
    s_add_u32 m0, s61, 4096
    s_add_u32 s88, s62, 4096
    buffer_load_dwordx4 v3, s[8:11], s88 offen offset:0 sc1 lds
    buffer_load_dwordx4 v3, s[8:11], s88 offen offset:1024 sc1 lds
    buffer_load_dwordx4 v3, s[8:11], s88 offen offset:2048 sc1 lds
    buffer_load_dwordx4 v3, s[8:11], s88 offen offset:3072 sc1 lds
    s_cmp_lt_u32 s46, 2
    s_cbranch_scc0 K2_NZ2
    s_lshl_b32 s61, s46, 10
    s_add_u32 m0, s61, 131072
    s_add_u32 s88, s61, 7766016
    buffer_load_dwordx4 v3, s[8:11], s88 offen sc1 lds
K2_NZ2:
    s_mov_b32 m0, s58
    s_nop 0
    buffer_load_dwordx4 v3, s[8:11], s56 offen sc1 lds
    buffer_load_dwordx4 v3, s[8:11], s56 offen offset:1024 sc1 lds
    s_add_u32 m0, s58, 8192
    s_nop 0
    buffer_load_dwordx4 v3, s[8:11], s57 offen sc1 lds
    buffer_load_dwordx4 v3, s[8:11], s57 offen offset:1024 sc1 lds
    s_mov_b32 m0, s59
    s_nop 0
    buffer_load_dwordx4 v4, s[12:15], s60 offen lds
    s_add_u32 m0, s59, 1024
    s_nop 0
    buffer_load_dwordx4 v5, s[12:15], s60 offen lds
    s_add_u32 m0, s59, 2048
    s_nop 0
    buffer_load_dwordx4 v6, s[12:15], s60 offen lds
    s_add_u32 m0, s59, 3072
    s_nop 0
    buffer_load_dwordx4 v7, s[12:15], s60 offen lds
    s_add_u32 s58, s53, s54
    s_add_u32 s59, s53, s55
    s_bitcmp1_b32 s40, s52
    s_cbranch_scc1 K2_AD_7A
    s_lshl_b32 s56, s41, 2
    s_add_u32 s56, s56, s46
    s_and_b32 s57, s56, 1
    s_mul_i32 s57, s57, 3
    s_lshr_b32 s60, s56, 4
    s_add_u32 s57, s57, s60
    s_and_b32 s61, s56, 15
    s_lshr_b32 s61, s61, 1
    s_cmp_lt_u32 s56, 38
    s_cbranch_scc1 K2_AD_7T
    s_sub_u32 s61, s56, 35
    s_mov_b32 s57, 2
K2_AD_7T:
    s_mul_i32 s62, s61, 6
    s_mul_i32 s61, s61, 5
    s_add_u32 s61, s61, 3
    s_min_u32 s61, s61, s62
    s_add_u32 s61, s61, s57
    s_cmp_eq_u32 s56, 43
    s_cselect_b32 s61, 43, s61
    s_lshl_b32 s56, s61, 11
    s_add_u32 s56, s56, s47
    s_add_u32 s57, s56, 88064
    s_lshl_b32 s60, s61, 15
    s_add_u32 s41, s41, 1
    s_mov_b32 s12, s32
    s_and_b32 s13, s33, 0xffff
    s_mov_b32 s14, 1409024
    s_branch K2_AD_7E
K2_AD_7A:
    s_lshl_b32 s56, s42, 13
    s_add_u32 s56, s56, s48
    s_add_u32 s57, s56, 32768
    s_lshl_b32 s60, s42, 17
    s_lshl_b32 s61, s46, 15
    s_add_u32 s60, s60, s61
    s_add_u32 s42, s42, 1
    s_mov_b32 s12, s30
    s_and_b32 s13, s31, 0xffff
    s_mov_b32 s14, 524288
K2_AD_7E:
    s_add_u32 s52, s52, 1
    s_add_u32 s53, s53, s64
    s_cmp_eq_u32 s53, 98304
    s_cselect_b32 s53, 0, s53
    s_waitcnt vmcnt(16)
    s_barrier
    s_mov_b32 m0, s58
    s_nop 0
    buffer_load_dwordx4 v3, s[8:11], s56 offen sc1 lds
    buffer_load_dwordx4 v3, s[8:11], s56 offen offset:1024 sc1 lds
    s_add_u32 m0, s58, 8192
    s_nop 0
    buffer_load_dwordx4 v3, s[8:11], s57 offen sc1 lds
    buffer_load_dwordx4 v3, s[8:11], s57 offen offset:1024 sc1 lds
    s_mov_b32 m0, s59
    s_nop 0
    buffer_load_dwordx4 v4, s[12:15], s60 offen lds
    s_add_u32 m0, s59, 1024
    s_nop 0
    buffer_load_dwordx4 v5, s[12:15], s60 offen lds
    s_add_u32 m0, s59, 2048
    s_nop 0
    buffer_load_dwordx4 v6, s[12:15], s60 offen lds
    s_add_u32 m0, s59, 3072
    s_nop 0
    buffer_load_dwordx4 v7, s[12:15], s60 offen lds
    s_mov_b32 s51, 6
K2_LL:
    s_cmp_ge_u32 s52, 15
    s_cbranch_scc1 K2_LNA
    s_add_u32 s58, s53, s54
    s_add_u32 s59, s53, s55
    s_bitcmp1_b32 s40, s52
    s_cbranch_scc1 K2_AD_8A
    s_lshl_b32 s56, s41, 2
    s_add_u32 s56, s56, s46
    s_and_b32 s57, s56, 1
    s_mul_i32 s57, s57, 3
    s_lshr_b32 s60, s56, 4
    s_add_u32 s57, s57, s60
    s_and_b32 s61, s56, 15
    s_lshr_b32 s61, s61, 1
    s_cmp_lt_u32 s56, 38
    s_cbranch_scc1 K2_AD_8T
    s_sub_u32 s61, s56, 35
    s_mov_b32 s57, 2
K2_AD_8T:
    s_mul_i32 s62, s61, 6
    s_mul_i32 s61, s61, 5
    s_add_u32 s61, s61, 3
    s_min_u32 s61, s61, s62
    s_add_u32 s61, s61, s57
    s_cmp_eq_u32 s56, 43
    s_cselect_b32 s61, 43, s61
    s_lshl_b32 s56, s61, 11
    s_add_u32 s56, s56, s47
    s_add_u32 s57, s56, 88064
    s_lshl_b32 s60, s61, 15
    s_add_u32 s41, s41, 1
    s_mov_b32 s12, s32
    s_and_b32 s13, s33, 0xffff
    s_mov_b32 s14, 1409024
    s_branch K2_AD_8E
K2_AD_8A:
    s_lshl_b32 s56, s42, 13
    s_add_u32 s56, s56, s48
    s_add_u32 s57, s56, 32768
    s_lshl_b32 s60, s42, 17
    s_lshl_b32 s61, s46, 15
    s_add_u32 s60, s60, s61
    s_add_u32 s42, s42, 1
    s_mov_b32 s12, s30
    s_and_b32 s13, s31, 0xffff
    s_mov_b32 s14, 524288
K2_AD_8E:
    s_add_u32 s52, s52, 1
    s_add_u32 s53, s53, s64
    s_cmp_eq_u32 s53, 98304
    s_cselect_b32 s53, 0, s53
K2_LNA:
    s_cmp_eq_u32 s51, 14
    s_cbranch_scc1 K2_LW0
    s_waitcnt vmcnt(8)
    s_branch K2_LW1
K2_LW0:
    s_waitcnt vmcnt(0)
K2_LW1:
    s_barrier
    s_cmp_ge_u32 s51, 13
    s_cbranch_scc1 K2_LNI
    s_mov_b32 m0, s58
    s_nop 0
    buffer_load_dwordx4 v3, s[8:11], s56 offen sc1 lds
    buffer_load_dwordx4 v3, s[8:11], s56 offen offset:1024 sc1 lds
    s_add_u32 m0, s58, 8192
    s_nop 0
    buffer_load_dwordx4 v3, s[8:11], s57 offen sc1 lds
    buffer_load_dwordx4 v3, s[8:11], s57 offen offset:1024 sc1 lds
    s_mov_b32 m0, s59
    s_nop 0
    buffer_load_dwordx4 v4, s[12:15], s60 offen lds
    s_add_u32 m0, s59, 1024
    s_nop 0
    buffer_load_dwordx4 v5, s[12:15], s60 offen lds
    s_add_u32 m0, s59, 2048
    s_nop 0
    buffer_load_dwordx4 v6, s[12:15], s60 offen lds
    s_add_u32 m0, s59, 3072
    s_nop 0
    buffer_load_dwordx4 v7, s[12:15], s60 offen lds
K2_LNI:
    s_add_u32 s51, s51, 1
    s_cmp_lg_u32 s51, 15
    s_cbranch_scc1 K2_LL
    s_barrier
    s_branch K2_END
K2_CENTRY:
    s_mov_b32 s30, s82
    s_mov_b32 s31, s83
    s_mov_b32 s32, s84
    s_mov_b32 s33, s85
    s_mov_b32 s34, s92
    s_mov_b32 s35, s93
    s_mov_b32 s36, s94
    s_mov_b32 s37, s95
    s_and_b32 s8, s2, 7
    s_lshr_b32 s9, s2, 3
    s_and_b32 s4, s9, 3
    s_lshl_b32 s8, s8, 2
    s_add_u32 s4, s4, s8
    s_lshr_b32 s5, s9, 2
    s_mov_b32 s40, 21760
    s_mov_b32 s64, 32768
    s_mov_b32 s65, 0xffff0000
    s_and_b32 s46, s3, 1
    s_lshr_b32 s47, s3, 1
    v_lshrrev_b32 v7, 5, v2
    v_lshlrev_b32 v12, 4, v2
    s_lshl_b32 s48, s46, 13
    s_lshl_b32 s49, s47, 12
    s_add_u32 s48, s48, s49
    v_add_u32 v13, s48, v12
    v_and_b32 v14, 15, v2
    v_lshrrev_b32 v14, 2, v14
    v_lshl_add_u32 v14, v7, 2, v14
    v_lshlrev_b32 v14, 7, v14
    v_and_b32 v15, 3, v2
    v_lshlrev_b32 v15, 3, v15
    v_bfe_u32 v8, v2, 4, 1
    v_lshl_add_u32 v15, v8, 5, v15
    v_bfe_u32 v8, v2, 3, 1
    v_lshlrev_b32 v8, 6, v8
    v_xor_b32 v15, v15, v8
    s_lshl_b32 s48, s47, 13
    s_add_u32 s48, s48, 16384
    v_add3_u32 v14, v14, v15, s48
    v_xor_b32 v15, 64, v14
    s_lshl_b32 s48, s47, 6
    v_xor_b32 v14, s48, v14
    v_xor_b32 v15, s48, v15
    v_and_b32 v9, 31, v2
    v_lshl_add_u32 v10, v7, 4, v9
    v_lshlrev_b32 v10, 4, v10
    s_lshl_b32 s48, s47, 12
    s_add_u32 s48, s48, 98304
    v_add_u32 v10, s48, v10
    s_lshl_b32 s48, s47, 8
    s_add_u32 s48, s48, 131072
    v_lshl_add_u32 v11, v7, 4, s48
    v_cmp_gt_u32 vcc, 16, v9
    v_mov_b32 v18, 64
    v_mov_b32 v19, 0x400
    v_mov_b32 v20, 32
    v_mov_b32 v21, 0x200
    v_cndmask_b32 v18, v18, v19, vcc
    v_cndmask_b32 v20, v20, v21, vcc
    v_cndmask_b32 v10, v11, v10, vcc
    v_lshlrev_b32 v22, 1, v18
    v_lshlrev_b32 v23, 3, v18
    s_mov_b32 s41, 10944
    s_mov_b32 s74, 0x358637bd
    s_mov_b32 s52, 0
    s_mov_b32 s53, 0
    v_mov_b32 v128, 0
    v_mov_b32 v129, 0
    v_mov_b32 v130, 0
    v_mov_b32 v131, 0
    v_mov_b32 v132, 0
    v_mov_b32 v133, 0
    v_mov_b32 v134, 0
    v_mov_b32 v135, 0
    v_mov_b32 v136, 0
    v_mov_b32 v137, 0
    v_mov_b32 v138, 0
    v_mov_b32 v139, 0
    v_mov_b32 v140, 0
    v_mov_b32 v141, 0
    v_mov_b32 v142, 0
    v_mov_b32 v143, 0
    v_mov_b32 v144, 0
    v_mov_b32 v145, 0
    v_mov_b32 v146, 0
    v_mov_b32 v147, 0
    v_mov_b32 v148, 0
    v_mov_b32 v149, 0
    v_mov_b32 v150, 0
    v_mov_b32 v151, 0
    v_mov_b32 v152, 0
    v_mov_b32 v153, 0
    v_mov_b32 v154, 0
    v_mov_b32 v155, 0
    v_mov_b32 v156, 0
    v_mov_b32 v157, 0
    v_mov_b32 v158, 0
    v_mov_b32 v159, 0
    s_mov_b32 s8, s38
    s_and_b32 s9, s39, 0xffff
    s_mov_b32 s10, 8072192
    s_mov_b32 s11, 0x20000
    s_mov_b32 s20, s36
    s_and_b32 s21, s37, 0xffff
    s_mov_b32 s22, 2097152
    s_mov_b32 s23, 0x20000
    s_setprio 3
K2_CL:
    s_barrier
    s_bitcmp1_b32 s40, s52
    s_cbranch_scc1 K2_CA
    s_bitcmp1_b32 s41, s52
    s_cbranch_scc1 K2_CV
    ds_read_b128 v[64:67], v13 offset:0
    ds_read_b64_tr_b16 v[68:69], v14 offset:0
    ds_read_b64_tr_b16 v[70:71], v14 offset:1024
    ds_read_b64_tr_b16 v[72:73], v15 offset:0
    ds_read_b64_tr_b16 v[74:75], v15 offset:1024
    ds_read_b128 v[76:79], v13 offset:1024
    ds_read_b64_tr_b16 v[80:81], v14 offset:2048
    ds_read_b64_tr_b16 v[82:83], v14 offset:3072
    ds_read_b64_tr_b16 v[84:85], v15 offset:2048
    ds_read_b64_tr_b16 v[86:87], v15 offset:3072
    ds_read_b128 v[88:91], v13 offset:2048
    ds_read_b64_tr_b16 v[92:93], v14 offset:4096
    ds_read_b64_tr_b16 v[94:95], v14 offset:5120
    ds_read_b64_tr_b16 v[96:97], v15 offset:4096
    ds_read_b64_tr_b16 v[98:99], v15 offset:5120
    s_waitcnt lgkmcnt(12)
    v_mfma_f32_32x32x16_bf16 v[128:143], v[68:71], v[64:67], v[128:143]
    s_waitcnt lgkmcnt(10)
    v_mfma_f32_32x32x16_bf16 v[144:159], v[72:75], v[64:67], v[144:159]
    ds_read_b128 v[100:103], v13 offset:3072
    ds_read_b64_tr_b16 v[104:105], v14 offset:6144
    ds_read_b64_tr_b16 v[106:107], v14 offset:7168
    ds_read_b64_tr_b16 v[108:109], v15 offset:6144
    ds_read_b64_tr_b16 v[110:111], v15 offset:7168
    s_waitcnt lgkmcnt(12)
    v_mfma_f32_32x32x16_bf16 v[128:143], v[80:83], v[76:79], v[128:143]
    s_waitcnt lgkmcnt(10)
    v_mfma_f32_32x32x16_bf16 v[144:159], v[84:87], v[76:79], v[144:159]
    s_waitcnt lgkmcnt(7)
    v_mfma_f32_32x32x16_bf16 v[128:143], v[92:95], v[88:91], v[128:143]
    s_waitcnt lgkmcnt(5)
    v_mfma_f32_32x32x16_bf16 v[144:159], v[96:99], v[88:91], v[144:159]
    s_waitcnt lgkmcnt(2)
    v_mfma_f32_32x32x16_bf16 v[128:143], v[104:107], v[100:103], v[128:143]
    s_waitcnt lgkmcnt(0)
    v_mfma_f32_32x32x16_bf16 v[144:159], v[108:111], v[100:103], v[144:159]
    s_branch K2_CN
K2_CV:
    v_add_u32 v21, v10, v20
    v_add_u32 v26, v10, v18
    v_add_u32 v27, v21, v18
    ds_read_b128 v[112:115], v10
    ds_read_b128 v[116:119], v21
    ds_read_b128 v[120:123], v26
    ds_read_b128 v[124:127], v27
    v_add_u32 v10, v10, v22
    v_sub_u32 v22, v23, v22
    ds_read_b128 v[64:67], v13 offset:0
    ds_read_b64_tr_b16 v[68:69], v14 offset:0
    ds_read_b64_tr_b16 v[70:71], v14 offset:1024
    ds_read_b64_tr_b16 v[72:73], v15 offset:0
    ds_read_b64_tr_b16 v[74:75], v15 offset:1024
    ds_read_b128 v[76:79], v13 offset:1024
    ds_read_b64_tr_b16 v[80:81], v14 offset:2048
    ds_read_b64_tr_b16 v[82:83], v14 offset:3072
    ds_read_b64_tr_b16 v[84:85], v15 offset:2048
    ds_read_b64_tr_b16 v[86:87], v15 offset:3072
    v_mov_b32 v224, v232
    v_mov_b32 v225, v233
    v_mov_b32 v226, v234
    v_mov_b32 v227, v235
    v_mov_b32 v228, v236
    v_mov_b32 v229, v237
    v_mov_b32 v230, v238
    v_mov_b32 v231, v239
    s_waitcnt lgkmcnt(7)
    v_mfma_f32_32x32x16_bf16 v[128:143], v[68:71], v[64:67], v[128:143]
    v_cvt_pk_bf16_f32 v232, v112, v113
    v_cvt_pk_bf16_f32 v233, v114, v115
    v_cvt_pk_bf16_f32 v234, v116, v117
    v_cvt_pk_bf16_f32 v235, v118, v119
    s_waitcnt lgkmcnt(5)
    v_mfma_f32_32x32x16_bf16 v[144:159], v[72:75], v[64:67], v[144:159]
    ds_read_b128 v[88:91], v13 offset:2048
    ds_read_b64_tr_b16 v[92:93], v14 offset:4096
    ds_read_b64_tr_b16 v[94:95], v14 offset:5120
    ds_read_b64_tr_b16 v[96:97], v15 offset:4096
    ds_read_b64_tr_b16 v[98:99], v15 offset:5120
    v_cvt_pk_bf16_f32 v236, v120, v121
    v_cvt_pk_bf16_f32 v237, v122, v123
    v_cvt_pk_bf16_f32 v238, v124, v125
    v_cvt_pk_bf16_f32 v239, v126, v127
    s_waitcnt lgkmcnt(7)
    v_mfma_f32_32x32x16_bf16 v[128:143], v[80:83], v[76:79], v[128:143]
    s_waitcnt lgkmcnt(5)
    v_mfma_f32_32x32x16_bf16 v[144:159], v[84:87], v[76:79], v[144:159]
    ds_read_b128 v[100:103], v13 offset:3072
    ds_read_b64_tr_b16 v[104:105], v14 offset:6144
    ds_read_b64_tr_b16 v[106:107], v14 offset:7168
    ds_read_b64_tr_b16 v[108:109], v15 offset:6144
    ds_read_b64_tr_b16 v[110:111], v15 offset:7168
    s_waitcnt lgkmcnt(7)
    v_mfma_f32_32x32x16_bf16 v[128:143], v[92:95], v[88:91], v[128:143]
    s_waitcnt lgkmcnt(5)
    v_mfma_f32_32x32x16_bf16 v[144:159], v[96:99], v[88:91], v[144:159]
    s_waitcnt lgkmcnt(2)
    v_mfma_f32_32x32x16_bf16 v[128:143], v[104:107], v[100:103], v[128:143]
    s_waitcnt lgkmcnt(0)
    v_mfma_f32_32x32x16_bf16 v[144:159], v[108:111], v[100:103], v[144:159]
    s_branch K2_CN
K2_CA:
    ds_read_b128 v[64:67], v13 offset:0
    ds_read_b128 v[68:71], v13 offset:1024
    ds_read_b128 v[72:75], v13 offset:2048
    ds_read_b128 v[76:79], v13 offset:3072
    ds_read_b64_tr_b16 v[80:81], v14 offset:0
    ds_read_b64_tr_b16 v[82:83], v14 offset:1024
    ds_read_b64_tr_b16 v[84:85], v15 offset:0
    ds_read_b64_tr_b16 v[86:87], v15 offset:1024
    ds_read_b64_tr_b16 v[88:89], v14 offset:2048
    ds_read_b64_tr_b16 v[90:91], v14 offset:3072
    ds_read_b64_tr_b16 v[92:93], v15 offset:2048
    ds_read_b64_tr_b16 v[94:95], v15 offset:3072
    s_waitcnt lgkmcnt(11)
    v_mfma_f32_32x32x16_bf16 v[160:175], v[224:227], v[64:67], 0
    s_waitcnt lgkmcnt(10)
    v_mfma_f32_32x32x16_bf16 v[176:191], v[228:231], v[68:71], 0
    s_waitcnt lgkmcnt(9)
    v_mfma_f32_32x32x16_bf16 v[192:207], v[232:235], v[72:75], 0
    s_waitcnt lgkmcnt(8)
    v_mfma_f32_32x32x16_bf16 v[208:223], v[236:239], v[76:79], 0
    ds_read_b64_tr_b16 v[96:97], v14 offset:4096
    ds_read_b64_tr_b16 v[98:99], v14 offset:5120
    ds_read_b64_tr_b16 v[100:101], v15 offset:4096
    ds_read_b64_tr_b16 v[102:103], v15 offset:5120
    s_nop 3
    v_add_f32 v8, s74, v168
    v_rcp_f32 v8, v8
    v_add_f32 v9, s74, v184
    v_rcp_f32 v9, v9
    v_mul_f32 v160, v160, v8
    v_mul_f32 v161, v161, v8
    v_mul_f32 v162, v162, v8
    v_mul_f32 v163, v163, v8
    v_mul_f32 v164, v164, v8
    v_mul_f32 v165, v165, v8
    v_mul_f32 v166, v166, v8
    v_mul_f32 v167, v167, v8
    v_cvt_pk_bf16_f32 v32, v160, v161
    v_cvt_pk_bf16_f32 v33, v162, v163
    v_cvt_pk_bf16_f32 v34, v164, v165
    v_cvt_pk_bf16_f32 v35, v166, v167
    s_nop 1
    s_waitcnt lgkmcnt(10)
    v_mfma_f32_32x32x16_bf16 v[128:143], v[80:83], v[32:35], v[128:143]
    v_mul_f32 v176, v176, v9
    v_mul_f32 v177, v177, v9
    v_mul_f32 v178, v178, v9
    v_mul_f32 v179, v179, v9
    s_waitcnt lgkmcnt(8)
    v_mfma_f32_32x32x16_bf16 v[144:159], v[84:87], v[32:35], v[144:159]
    ds_read_b64_tr_b16 v[104:105], v14 offset:6144
    ds_read_b64_tr_b16 v[106:107], v14 offset:7168
    ds_read_b64_tr_b16 v[108:109], v15 offset:6144
    ds_read_b64_tr_b16 v[110:111], v15 offset:7168
    v_mul_f32 v180, v180, v9
    v_mul_f32 v181, v181, v9
    v_mul_f32 v182, v182, v9
    v_mul_f32 v183, v183, v9
    v_cvt_pk_bf16_f32 v36, v176, v177
    v_cvt_pk_bf16_f32 v37, v178, v179
    v_cvt_pk_bf16_f32 v38, v180, v181
    v_cvt_pk_bf16_f32 v39, v182, v183
    v_add_f32 v8, s74, v200
    v_rcp_f32 v8, v8
    s_waitcnt lgkmcnt(10)
    v_mfma_f32_32x32x16_bf16 v[128:143], v[88:91], v[36:39], v[128:143]
    v_add_f32 v9, s74, v216
    v_mul_f32 v192, v192, v8
    v_mul_f32 v193, v193, v8
    v_mul_f32 v194, v194, v8
    v_mul_f32 v195, v195, v8
    s_waitcnt lgkmcnt(8)
    v_mfma_f32_32x32x16_bf16 v[144:159], v[92:95], v[36:39], v[144:159]
    v_add_u32 v21, v10, v20
    v_add_u32 v26, v10, v18
    v_add_u32 v27, v21, v18
    ds_read_b128 v[112:115], v10
    ds_read_b128 v[116:119], v21
    ds_read_b128 v[120:123], v26
    ds_read_b128 v[124:127], v27
    v_add_u32 v10, v10, v22
    v_sub_u32 v22, v23, v22
    v_rcp_f32 v9, v9
    v_mul_f32 v196, v196, v8
    v_mul_f32 v197, v197, v8
    v_mul_f32 v198, v198, v8
    v_mul_f32 v199, v199, v8
    v_cvt_pk_bf16_f32 v32, v192, v193
    v_cvt_pk_bf16_f32 v33, v194, v195
    v_cvt_pk_bf16_f32 v34, v196, v197
    v_cvt_pk_bf16_f32 v35, v198, v199
    s_nop 0
    s_waitcnt lgkmcnt(10)
    v_mfma_f32_32x32x16_bf16 v[128:143], v[96:99], v[32:35], v[128:143]
    v_mul_f32 v208, v208, v9
    v_mul_f32 v209, v209, v9
    v_mul_f32 v210, v210, v9
    v_mul_f32 v211, v211, v9
    s_waitcnt lgkmcnt(8)
    v_mfma_f32_32x32x16_bf16 v[144:159], v[100:103], v[32:35], v[144:159]
    v_mul_f32 v212, v212, v9
    v_mul_f32 v213, v213, v9
    v_mul_f32 v214, v214, v9
    v_mul_f32 v215, v215, v9
    v_cvt_pk_bf16_f32 v36, v208, v209
    v_cvt_pk_bf16_f32 v37, v210, v211
    v_cvt_pk_bf16_f32 v38, v212, v213
    v_cvt_pk_bf16_f32 v39, v214, v215
    s_nop 1
    s_waitcnt lgkmcnt(6)
    v_mfma_f32_32x32x16_bf16 v[128:143], v[104:107], v[36:39], v[128:143]
    s_waitcnt lgkmcnt(4)
    v_mfma_f32_32x32x16_bf16 v[144:159], v[108:111], v[36:39], v[144:159]
    s_waitcnt lgkmcnt(2)
    v_cvt_pk_bf16_f32 v232, v112, v113
    v_cvt_pk_bf16_f32 v233, v114, v115
    v_cvt_pk_bf16_f32 v234, v116, v117
    v_cvt_pk_bf16_f32 v235, v118, v119
    s_waitcnt lgkmcnt(0)
    v_cvt_pk_bf16_f32 v236, v120, v121
    v_cvt_pk_bf16_f32 v237, v122, v123
    v_cvt_pk_bf16_f32 v238, v124, v125
    v_cvt_pk_bf16_f32 v239, v126, v127
K2_CN:
    s_waitcnt lgkmcnt(0)
    s_add_u32 s53, s53, s64
    s_cmp_eq_u32 s53, 98304
    s_cselect_b32 s50, s65, s64
    s_cselect_b32 s53, 0, s53
    v_add_u32 v13, s50, v13
    v_add_u32 v14, s50, v14
    v_add_u32 v15, s50, v15
    s_add_u32 s52, s52, 1
    s_cmp_lg_u32 s52, 15
    s_cbranch_scc1 K2_CL
    s_lshl_b32 s48, s3, 12
    v_add_u32 v16, s48, v12
    s_xor_b32 s48, s3, 2
    s_lshl_b32 s48, s48, 12
    v_add_u32 v18, s48, v12
    v_and_b32 v9, 31, v2
    s_lshl_b32 s48, s46, 5
    v_add_u32 v9, s48, v9
    v_and_b32 v10, 7, v9
    s_lshl_b32 s49, s47, 2
    v_lshlrev_b32 v11, 7, v9
    v_lshl_add_u32 v11, v7, 3, v11
    v_add_u32 v11, 133120, v11
    ds_write_b128 v16, v[144:147] offset:0
    ds_write_b128 v16, v[148:151] offset:1024
    ds_write_b128 v16, v[152:155] offset:2048
    ds_write_b128 v16, v[156:159] offset:3072
    v_lshlrev_b32 v12, 3, v7
    s_lshl_b32 s50, s47, 6
    v_add_u32 v12, s50, v12
    v_add_u32 v12, 141312, v12
    v_mov_b32 v16, s49
    v_add_u32 v16, 0, v16
    v_xor_b32 v16, v16, v10
    v_lshl_add_u32 v16, v16, 4, v11
    ds_read_b64 v[32:33], v16
    ds_read_b64 v[40:41], v12 offset:0
    v_mov_b32 v16, s49
    v_add_u32 v16, 1, v16
    v_xor_b32 v16, v16, v10
    v_lshl_add_u32 v16, v16, 4, v11
    ds_read_b64 v[34:35], v16
    ds_read_b64 v[42:43], v12 offset:16
    v_mov_b32 v16, s49
    v_add_u32 v16, 2, v16
    v_xor_b32 v16, v16, v10
    v_lshl_add_u32 v16, v16, 4, v11
    ds_read_b64 v[36:37], v16
    ds_read_b64 v[44:45], v12 offset:32
    v_mov_b32 v16, s49
    v_add_u32 v16, 3, v16
    v_xor_b32 v16, v16, v10
    v_lshl_add_u32 v16, v16, 4, v11
    ds_read_b64 v[38:39], v16
    ds_read_b64 v[46:47], v12 offset:48
    s_mov_b32 s70, 0xffff0000
    s_lshl_b32 s48, s4, 6
    v_add_u32 v17, s48, v9
    v_lshlrev_b32 v17, 10, v17
    s_lshl_b32 s48, s5, 7
    s_lshl_b32 s49, s47, 6
    s_add_u32 s48, s48, s49
    v_lshl_add_u32 v17, v7, 4, v17
    v_add_u32 v17, s48, v17
    s_waitcnt lgkmcnt(0)
    v_lshlrev_b32 v20, 16, v32
    v_and_b32 v21, s70, v32
    v_lshlrev_b32 v22, 16, v40
    v_and_b32 v23, s70, v40
    v_add_f32 v20, v20, v22
    v_add_f32 v21, v21, v23
    v_add_f32 v128, v20, v128
    v_add_f32 v129, v21, v129
    v_lshlrev_b32 v20, 16, v33
    v_and_b32 v21, s70, v33
    v_lshlrev_b32 v22, 16, v41
    v_and_b32 v23, s70, v41
    v_add_f32 v20, v20, v22
    v_add_f32 v21, v21, v23
    v_add_f32 v130, v20, v130
    v_add_f32 v131, v21, v131
    v_lshlrev_b32 v20, 16, v34
    v_and_b32 v21, s70, v34
    v_lshlrev_b32 v22, 16, v42
    v_and_b32 v23, s70, v42
    v_add_f32 v20, v20, v22
    v_add_f32 v21, v21, v23
    v_add_f32 v132, v20, v132
    v_add_f32 v133, v21, v133
    v_lshlrev_b32 v20, 16, v35
    v_and_b32 v21, s70, v35
    v_lshlrev_b32 v22, 16, v43
    v_and_b32 v23, s70, v43
    v_add_f32 v20, v20, v22
    v_add_f32 v21, v21, v23
    v_add_f32 v134, v20, v134
    v_add_f32 v135, v21, v135
    v_lshlrev_b32 v20, 16, v36
    v_and_b32 v21, s70, v36
    v_lshlrev_b32 v22, 16, v44
    v_and_b32 v23, s70, v44
    v_add_f32 v20, v20, v22
    v_add_f32 v21, v21, v23
    v_add_f32 v136, v20, v136
    v_add_f32 v137, v21, v137
    v_lshlrev_b32 v20, 16, v37
    v_and_b32 v21, s70, v37
    v_lshlrev_b32 v22, 16, v45
    v_and_b32 v23, s70, v45
    v_add_f32 v20, v20, v22
    v_add_f32 v21, v21, v23
    v_add_f32 v138, v20, v138
    v_add_f32 v139, v21, v139
    v_lshlrev_b32 v20, 16, v38
    v_and_b32 v21, s70, v38
    v_lshlrev_b32 v22, 16, v46
    v_and_b32 v23, s70, v46
    v_add_f32 v20, v20, v22
    v_add_f32 v21, v21, v23
    v_add_f32 v140, v20, v140
    v_add_f32 v141, v21, v141
    v_lshlrev_b32 v20, 16, v39
    v_and_b32 v21, s70, v39
    v_lshlrev_b32 v22, 16, v47
    v_and_b32 v23, s70, v47
    v_add_f32 v20, v20, v22
    v_add_f32 v21, v21, v23
    v_add_f32 v142, v20, v142
    v_add_f32 v143, v21, v143
    s_barrier
    ds_read_b128 v[144:147], v18 offset:0
    ds_read_b128 v[148:151], v18 offset:1024
    ds_read_b128 v[152:155], v18 offset:2048
    ds_read_b128 v[156:159], v18 offset:3072
    s_waitcnt lgkmcnt(3)
    v_add_f32 v128, v128, v144
    v_add_f32 v129, v129, v145
    v_add_f32 v130, v130, v146
    v_add_f32 v131, v131, v147
    v_cvt_pk_bf16_f32 v48, v128, v129
    v_cvt_pk_bf16_f32 v49, v130, v131
    s_waitcnt lgkmcnt(2)
    v_add_f32 v132, v132, v148
    v_add_f32 v133, v133, v149
    v_add_f32 v134, v134, v150
    v_add_f32 v135, v135, v151
    v_cvt_pk_bf16_f32 v50, v132, v133
    v_cvt_pk_bf16_f32 v51, v134, v135
    s_waitcnt lgkmcnt(1)
    v_add_f32 v136, v136, v152
    v_add_f32 v137, v137, v153
    v_add_f32 v138, v138, v154
    v_add_f32 v139, v139, v155
    v_cvt_pk_bf16_f32 v52, v136, v137
    v_cvt_pk_bf16_f32 v53, v138, v139
    s_waitcnt lgkmcnt(0)
    v_add_f32 v140, v140, v156
    v_add_f32 v141, v141, v157
    v_add_f32 v142, v142, v158
    v_add_f32 v143, v143, v159
    v_cvt_pk_bf16_f32 v54, v140, v141
    v_cvt_pk_bf16_f32 v55, v142, v143
    s_nop 1
    v_permlane32_swap_b32 v48, v50
    v_permlane32_swap_b32 v49, v51
    v_permlane32_swap_b32 v52, v54
    v_permlane32_swap_b32 v53, v55
    buffer_store_dwordx4 v[48:51], v17, s[20:23], 0 offen
    buffer_store_dwordx4 v[52:55], v17, s[20:23], 0 offen offset:32
K2_END:
    s_endpgm
K_TEXT_END:
    s_endpgm
.section .rodata,"a"
.p2align 6
.amdhsa_kernel parallel_sum__linear_attn_block__dense_activation_gelu__prompt_kernel
  .amdhsa_next_free_vgpr 240
  .amdhsa_next_free_sgpr 102
  .amdhsa_accum_offset 240
  .amdhsa_group_segment_fixed_size 0
  .amdhsa_kernarg_size 88
  .amdhsa_user_sgpr_count 2
  .amdhsa_user_sgpr_kernarg_segment_ptr 1
  .amdhsa_system_sgpr_workgroup_id_x 1
.end_amdhsa_kernel
```
